```python
import torch

def _softmax(x, axis=-1):
    return torch.softmax(x, dim=axis)
def _gelu(x):
    return torch.nn.functional.gelu(x, approximate="tanh")
def _silu(x):
    return torch.nn.functional.silu(x)
def _sigmoid(x):
    return torch.sigmoid(x)
def _layernorm(x, axis=-1, eps=1e-5):
    m = x.mean(dim=axis, keepdim=True)
    v = x.var(dim=axis, keepdim=True, unbiased=False)
    return (x - m) / torch.sqrt(v + eps)
def _scatter_add(tgt, idx, src, axis=0):
    return tgt.clone().index_add_(axis, idx, src)
def _segment_sum(src, seg, n):
    out = torch.zeros((n,) + src.shape[1:], dtype=src.dtype)
    return out.index_add_(0, seg, src)
def _pad(x, pw):
    flat = tuple(v for pair in reversed(pw) for v in pair)
    return torch.nn.functional.pad(x, flat)

kernel_name = 'parallel_sum__mha_block_cached__glu_gated_reglu__decode'

def setup_inputs():

    _w = (lambda a: (lambda t: t.to(torch.bfloat16) if t.is_floating_point() else t)(torch.as_tensor(a)))
    def _A_setup():
        B, Sq, D = 1, 1, 640
        H, Sk, Dh = 32, 32768, 192
        return {
            "x": _w((lambda *s: torch.randn(*s, dtype=torch.bfloat16) * 0.05)(B, Sq, D)),
            "k_cache": _w((lambda *s: torch.randn(*s, dtype=torch.bfloat16) * 3.2)(B, H, Sk, Dh)),
            "v_cache": _w((lambda *s: torch.randn(*s, dtype=torch.bfloat16) * 1.6)(B, H, Sk, Dh)),
            "wq": _w((lambda *s: torch.randn(*s, dtype=torch.bfloat16) * 3.2)(D, H * Dh) * (D ** -0.5)),
            "wo": _w((lambda *s: torch.randn(*s, dtype=torch.bfloat16) * 1.6)(H * Dh, D) * ((H * Dh) ** -0.5)),
        }
    _A_in = _A_setup()

    def _B_setup():
        B, S, D, F = 1, 1, 640, 1536
        return {
            "x": _w((lambda *s: torch.randn(*s, dtype=torch.bfloat16) * 0.05)(B, S, D)),
            "W_gate": _w((lambda *s: torch.randn(*s, dtype=torch.bfloat16) * 1.6)(D, F) * (2.0 / D) ** 0.5),
            "W_up": _w((lambda *s: torch.randn(*s, dtype=torch.bfloat16) * 1.6)(D, F) * (2.0 / D) ** 0.5),
            "W_down": _w((lambda *s: torch.randn(*s, dtype=torch.bfloat16) * 1.6)(F, D) * (1.0 / F) ** 0.5),
        }
    _B_in = _B_setup()

    return {
        "A_x": _A_in["x"],
        "A_k_cache": _A_in["k_cache"],
        "A_v_cache": _A_in["v_cache"],
        "A_wq": _A_in["wq"],
        "A_wo": _A_in["wo"],
        "B_x": _B_in["x"],
        "B_W_gate": _B_in["W_gate"],
        "B_W_up": _B_in["W_up"],
        "B_W_down": _B_in["W_down"],
    }

def reference(A_x, A_k_cache, A_v_cache, A_wq, A_wo, B_x, B_W_gate, B_W_up, B_W_down):
    def _A_ref(x, k_cache, v_cache, wq, wo):
        B, Sq, D = x.shape
        H, Dh = 32, 192
        q = (lambda x, *d: x.permute(*d))((x @ wq).reshape(B, Sq, H, Dh), 0, 2, 1, 3)
        scores = torch.einsum("bhqd,bhkd->bhqk", q, k_cache) * (Dh ** -0.5)
        p = _softmax(scores, axis=-1)
        o = torch.einsum("bhqk,bhkd->bhqd", p, v_cache)
        return (lambda x, *d: x.permute(*d))(o, 0, 2, 1, 3).reshape(B, Sq, H * Dh) @ wo

    def _B_ref(x, W_gate, W_up, W_down):
        gate = torch.einsum("bsd,df->bsf", x, W_gate)
        up = torch.einsum("bsd,df->bsf", x, W_up)
        gate = gate * (lambda x, dt: x.to(dt))(gate > 0, gate.dtype)
        h = gate * up
        return torch.einsum("bsf,fd->bsd", h, W_down)

    x = A_x
    xn = _layernorm(x, axis=-1)
    return x + _A_ref(xn, A_k_cache, A_v_cache, A_wq, A_wo) + _B_ref(xn, B_W_gate, B_W_up, B_W_down)
```

```asm
; @launch grid=(256,1,1) block=(384,1,1) lds=114176
.amdgcn_target "amdgcn-amd-amdhsa--gfx950"
.text
.globl parallel_sum__mha_block_cached__glu_gated_reglu__decode_kernel
.p2align 12
.p2align 8
.type parallel_sum__mha_block_cached__glu_gated_reglu__decode_kernel,@function
parallel_sum__mha_block_cached__glu_gated_reglu__decode_kernel:
  s_load_dwordx16 s[36:51], s[0:1], 0
  s_load_dwordx8 s[52:59], s[0:1], 64
  s_cmp_ge_u32 s2, 256
  s_cbranch_scc1 L_end
  v_lshrrev_b32 v3, 6, v0
  v_and_b32 v1, 63, v0
  v_readfirstlane_b32 s3, v3
  s_and_b32 s4, s2, 7
  s_lshr_b32 s5, s2, 3
  v_lshrrev_b32 v9, 3, v1
  v_and_b32 v10, 7, v1
  v_lshlrev_b32 v12, 4, v1
  v_mov_b32 v13, 0
  s_cmp_eq_u32 s3, 0
  s_cbranch_scc1 L_help
  s_cmp_eq_u32 s3, 5
  s_cbranch_scc0 L_stream
  s_barrier
  s_branch L_ctl
L_help:
  v_lshlrev_b32 v15, 2, v1
  v_mul_u32_u24 v14, 12288, v9
  v_lshl_add_u32 v14, v10, 4, v14
  s_and_b32 s28, s5, 7
  s_mul_i32 s29, s28, 80
  s_mul_i32 s28, s29, 12288
  s_andn2_b32 s30, 24, s5
  s_add_u32 s30, s30, s4
  s_mul_i32 s30, s30, 384
  s_add_u32 s28, s28, s30
  s_mov_b32 s30, 98304
  s_getreg_b32 s20, hwreg(20, 0, 4)
  s_or_b32 s21, s20, 0x80
  v_mov_b32 v3, s21
  s_lshl_b32 s22, s4, 5
  s_add_u32 s23, s22, s5
  v_and_b32 v2, 31, v1
  s_setprio 2
  s_mov_b32 s26, 256
  s_mov_b32 s27, 0x20000
  s_mov_b32 s10, 1280
  s_mov_b32 s11, 0x20000
  s_mov_b32 s14, 7864320
  s_mov_b32 s15, 0x20000
  s_waitcnt lgkmcnt(0)
  s_mov_b64 s[24:25], s[56:57]
  s_mov_b64 exec, 1
  buffer_store_byte v3, v13, s[24:27], s23 offen
  s_mov_b64 exec, -1
  s_mov_b64 s[12:13], s[42:43]
  buffer_load_dwordx4 v[16:19], v14, s[12:15], s28 offen offset:0 nt
  buffer_load_dwordx4 v[20:23], v14, s[12:15], s28 offen offset:128 nt
  buffer_load_dwordx4 v[24:27], v14, s[12:15], s28 offen offset:256 nt
  s_add_u32 s28, s28, s30
  buffer_load_dwordx4 v[28:31], v14, s[12:15], s28 offen offset:0 nt
  buffer_load_dwordx4 v[32:35], v14, s[12:15], s28 offen offset:128 nt
  buffer_load_dwordx4 v[36:39], v14, s[12:15], s28 offen offset:256 nt
  s_add_u32 s28, s28, s30
  s_mov_b64 s[8:9], s[36:37]
  buffer_load_dword v146, v15, s[8:11], 0 offen offset:0
  buffer_load_dword v147, v15, s[8:11], 0 offen offset:256
  buffer_load_dword v148, v15, s[8:11], 0 offen offset:512
  buffer_load_dword v149, v15, s[8:11], 0 offen offset:768
  buffer_load_dword v150, v15, s[8:11], 0 offen offset:1024
  s_load_dword s6, s[58:59], 0
  buffer_load_dwordx4 v[40:43], v14, s[12:15], s28 offen offset:0 nt
  buffer_load_dwordx4 v[44:47], v14, s[12:15], s28 offen offset:128 nt
  buffer_load_dwordx4 v[48:51], v14, s[12:15], s28 offen offset:256 nt
  s_add_u32 s28, s28, s30
  buffer_load_dwordx4 v[52:55], v14, s[12:15], s28 offen offset:0 nt
  buffer_load_dwordx4 v[56:59], v14, s[12:15], s28 offen offset:128 nt
  buffer_load_dwordx4 v[60:63], v14, s[12:15], s28 offen offset:256 nt
  s_add_u32 s28, s28, s30
  buffer_load_dwordx4 v[64:67], v14, s[12:15], s28 offen offset:0 nt
  buffer_load_dwordx4 v[68:71], v14, s[12:15], s28 offen offset:128 nt
  buffer_load_dwordx4 v[72:75], v14, s[12:15], s28 offen offset:256 nt
  s_add_u32 s28, s28, s30
  buffer_load_dwordx4 v[76:79], v14, s[12:15], s28 offen offset:0 nt
  buffer_load_dwordx4 v[80:83], v14, s[12:15], s28 offen offset:128 nt
  buffer_load_dwordx4 v[84:87], v14, s[12:15], s28 offen offset:256 nt
  s_add_u32 s28, s28, s30
  buffer_load_dwordx4 v[88:91], v14, s[12:15], s28 offen offset:0 nt
  buffer_load_dwordx4 v[92:95], v14, s[12:15], s28 offen offset:128 nt
  buffer_load_dwordx4 v[96:99], v14, s[12:15], s28 offen offset:256 nt
  s_add_u32 s28, s28, s30
  buffer_load_dwordx4 v[100:103], v14, s[12:15], s28 offen offset:0 nt
  buffer_load_dwordx4 v[104:107], v14, s[12:15], s28 offen offset:128 nt
  buffer_load_dwordx4 v[108:111], v14, s[12:15], s28 offen offset:256 nt
  s_add_u32 s28, s28, s30
  buffer_load_dwordx4 v[112:115], v14, s[12:15], s28 offen offset:0 nt
  buffer_load_dwordx4 v[116:119], v14, s[12:15], s28 offen offset:128 nt
  buffer_load_dwordx4 v[120:123], v14, s[12:15], s28 offen offset:256 nt
  s_add_u32 s28, s28, s30
  buffer_load_dwordx4 v[124:127], v14, s[12:15], s28 offen offset:0 nt
  buffer_load_dwordx4 v[128:131], v14, s[12:15], s28 offen offset:128 nt
  buffer_load_dwordx4 v[132:135], v14, s[12:15], s28 offen offset:256 nt
  buffer_load_ubyte v168, v2, s[24:27], s22 offen sc1
  s_mov_b64 s[16:17], s[58:59]
  s_mov_b32 s18, 1572864
  s_mov_b32 s19, 0x20000
  s_mul_i32 s28, s23, 1536
  s_add_u32 s28, s28, 524288
  v_lshlrev_b32 v2, 7, v1
  s_mov_b64 exec, 0xfff
  buffer_load_dword v169, v2, s[16:19], s28 offen nt
  s_mov_b64 exec, -1
  s_barrier
  v_and_b32 v3, 1, v10
  v_lshlrev_b32 v3, 4, v3
  v_mov_b32 v8, 0xffff
  v_lshlrev_b32 v8, v3, v8
  v_lshrrev_b32 v3, 1, v10
  v_cmp_eq_u32 vcc, 0, v3
  s_nop 1
  v_cndmask_b32 v4, 0, v8, vcc
  v_cmp_eq_u32 vcc, 1, v3
  s_nop 1
  v_cndmask_b32 v5, 0, v8, vcc
  v_cmp_eq_u32 vcc, 2, v3
  s_nop 1
  v_cndmask_b32 v6, 0, v8, vcc
  v_cmp_eq_u32 vcc, 3, v3
  s_nop 1
  v_cndmask_b32 v7, 0, v8, vcc
  v_lshrrev_b32 v3, 5, v1
  v_mul_u32_u24 v11, 768, v3
  v_lshl_add_u32 v11, v10, 5, v11
  v_and_b32 v3, 16, v1
  v_add_u32 v11, v11, v3
  s_mov_b32 s34, 0x00ff00ff
  s_mov_b32 s35, 0xff00ff00
  s_mov_b32 s7, 0x3acccccd
  s_waitcnt vmcnt(26)
  v_lshlrev_b32 v136, 16, v146
  v_and_b32 v137, 0xffff0000, v146
  v_lshlrev_b32 v138, 16, v147
  v_and_b32 v139, 0xffff0000, v147
  v_lshlrev_b32 v140, 16, v148
  v_and_b32 v141, 0xffff0000, v148
  v_lshlrev_b32 v142, 16, v149
  v_and_b32 v143, 0xffff0000, v149
  v_lshlrev_b32 v144, 16, v150
  v_and_b32 v145, 0xffff0000, v150
  v_pk_add_f32 v[152:153], v[136:137], v[138:139]
  v_pk_add_f32 v[154:155], v[140:141], v[142:143]
  v_pk_add_f32 v[152:153], v[152:153], v[144:145]
  v_pk_add_f32 v[152:153], v[152:153], v[154:155]
  v_add_f32 v152, v152, v153
  s_nop 1
  v_add_f32_dpp v152, v152, v152 quad_perm:[1,0,3,2] row_mask:0xf bank_mask:0xf
  s_nop 1
  v_add_f32_dpp v152, v152, v152 quad_perm:[2,3,0,1] row_mask:0xf bank_mask:0xf
  s_nop 1
  v_add_f32_dpp v152, v152, v152 row_half_mirror row_mask:0xf bank_mask:0xf
  s_nop 1
  v_add_f32_dpp v152, v152, v152 row_mirror row_mask:0xf bank_mask:0xf
  v_mov_b32 v146, v152
  s_nop 1
  v_permlane16_swap_b32 v152, v146
  v_add_f32 v152, v152, v146
  v_mov_b32 v146, v152
  s_nop 1
  v_permlane32_swap_b32 v152, v146
  v_add_f32 v152, v152, v146
  v_mul_f32 v152, s7, v152
  v_sub_f32 v146, v136, v152
  v_mul_f32 v154, v146, v146
  v_sub_f32 v147, v137, v152
  v_fmac_f32 v154, v147, v147
  v_sub_f32 v146, v138, v152
  v_fmac_f32 v154, v146, v146
  v_sub_f32 v147, v139, v152
  v_fmac_f32 v154, v147, v147
  v_sub_f32 v146, v140, v152
  v_fmac_f32 v154, v146, v146
  v_sub_f32 v147, v141, v152
  v_fmac_f32 v154, v147, v147
  v_sub_f32 v146, v142, v152
  v_fmac_f32 v154, v146, v146
  v_sub_f32 v147, v143, v152
  v_fmac_f32 v154, v147, v147
  v_sub_f32 v146, v144, v152
  v_fmac_f32 v154, v146, v146
  v_sub_f32 v147, v145, v152
  v_fmac_f32 v154, v147, v147
  s_nop 1
  v_add_f32_dpp v154, v154, v154 quad_perm:[1,0,3,2] row_mask:0xf bank_mask:0xf
  s_nop 1
  v_add_f32_dpp v154, v154, v154 quad_perm:[2,3,0,1] row_mask:0xf bank_mask:0xf
  s_nop 1
  v_add_f32_dpp v154, v154, v154 row_half_mirror row_mask:0xf bank_mask:0xf
  s_nop 1
  v_add_f32_dpp v154, v154, v154 row_mirror row_mask:0xf bank_mask:0xf
  v_mov_b32 v146, v154
  s_nop 1
  v_permlane16_swap_b32 v154, v146
  v_add_f32 v154, v154, v146
  v_mov_b32 v146, v154
  s_nop 1
  v_permlane32_swap_b32 v154, v146
  v_add_f32 v154, v154, v146
  v_mul_f32 v154, s7, v154
  v_xor_b32 v147, v152, v154
  v_cvt_pk_bf16_f32 v146, v152, v154
  v_readfirstlane_b32 s76, v147
  v_lshlrev_b32 v152, 16, v146
  v_and_b32 v154, 0xffff0000, v146
  v_add_f32 v154, 0x3727c5ac, v154
  v_cvt_pk_bf16_f32 v154, v154, v154
  v_lshlrev_b32 v154, 16, v154
  v_sqrt_f32 v154, v154
  s_nop 0
  v_cvt_pk_bf16_f32 v154, v154, v154
  v_lshlrev_b32 v154, 16, v154
  v_rcp_f32 v154, v154
  v_lshlrev_b32 v15, 3, v1
  v_sub_f32 v136, v136, v152
  v_sub_f32 v137, v137, v152
  v_cvt_pk_bf16_f32 v137, v136, v137
  v_lshlrev_b32 v136, 16, v137
  v_and_b32 v137, 0xffff0000, v137
  v_mul_f32 v136, v136, v154
  v_mul_f32 v137, v137, v154
  v_cvt_pk_bf16_f32 v136, v136, v136
  v_cvt_pk_bf16_f32 v137, v137, v137
  ds_write_b64 v15, v[136:137] offset:3584
  v_sub_f32 v138, v138, v152
  v_sub_f32 v139, v139, v152
  v_cvt_pk_bf16_f32 v139, v138, v139
  v_lshlrev_b32 v138, 16, v139
  v_and_b32 v139, 0xffff0000, v139
  v_mul_f32 v138, v138, v154
  v_mul_f32 v139, v139, v154
  v_cvt_pk_bf16_f32 v138, v138, v138
  v_cvt_pk_bf16_f32 v139, v139, v139
  ds_write_b64 v15, v[138:139] offset:4096
  v_sub_f32 v140, v140, v152
  v_sub_f32 v141, v141, v152
  v_cvt_pk_bf16_f32 v141, v140, v141
  v_lshlrev_b32 v140, 16, v141
  v_and_b32 v141, 0xffff0000, v141
  v_mul_f32 v140, v140, v154
  v_mul_f32 v141, v141, v154
  v_cvt_pk_bf16_f32 v140, v140, v140
  v_cvt_pk_bf16_f32 v141, v141, v141
  ds_write_b64 v15, v[140:141] offset:4608
  v_sub_f32 v142, v142, v152
  v_sub_f32 v143, v143, v152
  v_cvt_pk_bf16_f32 v143, v142, v143
  v_lshlrev_b32 v142, 16, v143
  v_and_b32 v143, 0xffff0000, v143
  v_mul_f32 v142, v142, v154
  v_mul_f32 v143, v143, v154
  v_cvt_pk_bf16_f32 v142, v142, v142
  v_cvt_pk_bf16_f32 v143, v143, v143
  ds_write_b64 v15, v[142:143] offset:5120
  v_sub_f32 v144, v144, v152
  v_sub_f32 v145, v145, v152
  v_cvt_pk_bf16_f32 v145, v144, v145
  v_lshlrev_b32 v144, 16, v145
  v_and_b32 v145, 0xffff0000, v145
  v_mul_f32 v144, v144, v154
  v_mul_f32 v145, v145, v154
  v_cvt_pk_bf16_f32 v144, v144, v144
  v_cvt_pk_bf16_f32 v145, v145, v145
  ds_write_b64 v15, v[144:145] offset:5632
  v_add_u32 v15, s29, v9
  v_lshlrev_b32 v15, 2, v15
  v_add_u32 v15, 3584, v15
  ds_read2_b32 v[136:137], v15 offset0:0 offset1:8
  ds_read2_b32 v[138:139], v15 offset0:16 offset1:24
  ds_read2_b32 v[140:141], v15 offset0:32 offset1:40
  ds_read2_b32 v[142:143], v15 offset0:48 offset1:56
  ds_read2_b32 v[144:145], v15 offset0:64 offset1:72
  s_waitcnt lgkmcnt(0)
  s_add_u32 s77, s6, 0x9e3779a0
  s_mul_i32 s76, s76, 0x85ebca6b
  s_xor_b32 s6, s77, s76
  s_and_b32 s6, s6, 0xffffffe0
  s_or_b32 s20, s20, s6
  v_and_b32 v160, v136, v4
  v_and_b32 v161, v136, v5
  v_and_b32 v162, v136, v6
  v_and_b32 v163, v136, v7
  s_waitcnt vmcnt(29)
  s_nop 0
  v_mfma_f32_16x16x32_bf16 v[148:151], v[160:163], v[16:19], 0
  v_mfma_f32_16x16x32_bf16 v[152:155], v[160:163], v[20:23], 0
  v_mfma_f32_16x16x32_bf16 v[156:159], v[160:163], v[24:27], 0
  v_and_b32 v164, v137, v4
  v_and_b32 v165, v137, v5
  v_and_b32 v166, v137, v6
  v_and_b32 v167, v137, v7
  s_waitcnt vmcnt(26)
  s_nop 0
  v_mfma_f32_16x16x32_bf16 v[148:151], v[164:167], v[28:31], v[148:151]
  v_mfma_f32_16x16x32_bf16 v[152:155], v[164:167], v[32:35], v[152:155]
  v_mfma_f32_16x16x32_bf16 v[156:159], v[164:167], v[36:39], v[156:159]
  v_and_b32 v160, v138, v4
  v_and_b32 v161, v138, v5
  v_and_b32 v162, v138, v6
  v_and_b32 v163, v138, v7
  s_waitcnt vmcnt(23)
  s_nop 0
  v_mfma_f32_16x16x32_bf16 v[148:151], v[160:163], v[40:43], v[148:151]
  v_mfma_f32_16x16x32_bf16 v[152:155], v[160:163], v[44:47], v[152:155]
  v_mfma_f32_16x16x32_bf16 v[156:159], v[160:163], v[48:51], v[156:159]
  v_and_b32 v164, v139, v4
  v_and_b32 v165, v139, v5
  v_and_b32 v166, v139, v6
  v_and_b32 v167, v139, v7
  s_waitcnt vmcnt(20)
  s_nop 0
  v_mfma_f32_16x16x32_bf16 v[148:151], v[164:167], v[52:55], v[148:151]
  v_mfma_f32_16x16x32_bf16 v[152:155], v[164:167], v[56:59], v[152:155]
  v_mfma_f32_16x16x32_bf16 v[156:159], v[164:167], v[60:63], v[156:159]
  v_and_b32 v160, v140, v4
  v_and_b32 v161, v140, v5
  v_and_b32 v162, v140, v6
  v_and_b32 v163, v140, v7
  s_waitcnt vmcnt(17)
  s_nop 0
  v_mfma_f32_16x16x32_bf16 v[148:151], v[160:163], v[64:67], v[148:151]
  v_mfma_f32_16x16x32_bf16 v[152:155], v[160:163], v[68:71], v[152:155]
  v_mfma_f32_16x16x32_bf16 v[156:159], v[160:163], v[72:75], v[156:159]
  v_and_b32 v164, v141, v4
  v_and_b32 v165, v141, v5
  v_and_b32 v166, v141, v6
  v_and_b32 v167, v141, v7
  s_waitcnt vmcnt(14)
  s_nop 0
  v_mfma_f32_16x16x32_bf16 v[148:151], v[164:167], v[76:79], v[148:151]
  v_mfma_f32_16x16x32_bf16 v[152:155], v[164:167], v[80:83], v[152:155]
  v_mfma_f32_16x16x32_bf16 v[156:159], v[164:167], v[84:87], v[156:159]
  v_and_b32 v160, v142, v4
  v_and_b32 v161, v142, v5
  v_and_b32 v162, v142, v6
  v_and_b32 v163, v142, v7
  s_waitcnt vmcnt(11)
  s_nop 0
  v_mfma_f32_16x16x32_bf16 v[148:151], v[160:163], v[88:91], v[148:151]
  v_mfma_f32_16x16x32_bf16 v[152:155], v[160:163], v[92:95], v[152:155]
  v_mfma_f32_16x16x32_bf16 v[156:159], v[160:163], v[96:99], v[156:159]
  v_and_b32 v164, v143, v4
  v_and_b32 v165, v143, v5
  v_and_b32 v166, v143, v6
  v_and_b32 v167, v143, v7
  s_waitcnt vmcnt(8)
  s_nop 0
  v_mfma_f32_16x16x32_bf16 v[148:151], v[164:167], v[100:103], v[148:151]
  v_mfma_f32_16x16x32_bf16 v[152:155], v[164:167], v[104:107], v[152:155]
  v_mfma_f32_16x16x32_bf16 v[156:159], v[164:167], v[108:111], v[156:159]
  v_and_b32 v160, v144, v4
  v_and_b32 v161, v144, v5
  v_and_b32 v162, v144, v6
  v_and_b32 v163, v144, v7
  s_waitcnt vmcnt(5)
  s_nop 0
  v_mfma_f32_16x16x32_bf16 v[148:151], v[160:163], v[112:115], v[148:151]
  v_mfma_f32_16x16x32_bf16 v[152:155], v[160:163], v[116:119], v[152:155]
  v_mfma_f32_16x16x32_bf16 v[156:159], v[160:163], v[120:123], v[156:159]
  v_and_b32 v164, v145, v4
  v_and_b32 v165, v145, v5
  v_and_b32 v166, v145, v6
  v_and_b32 v167, v145, v7
  s_waitcnt vmcnt(2)
  s_nop 0
  v_mfma_f32_16x16x32_bf16 v[148:151], v[164:167], v[124:127], v[148:151]
  v_mfma_f32_16x16x32_bf16 v[152:155], v[164:167], v[128:131], v[152:155]
  v_mfma_f32_16x16x32_bf16 v[156:159], v[164:167], v[132:135], v[156:159]
  v_mul_u32_u24 v14, 12, v1
  s_mul_i32 s30, s23, 1536
  s_add_u32 s30, s30, 524288
  s_mov_b64 exec, s[34:35]
  s_nop 1
  ds_write_b128 v11, v[148:151] offset:6144
  ds_write_b128 v11, v[152:155] offset:6400
  ds_write_b128 v11, v[156:159] offset:6656
  s_mov_b64 exec, -1
  ds_read_b32 v16, v14 offset:6144
  ds_read_b32 v17, v14 offset:6148
  ds_read_b32 v18, v14 offset:6152
  ds_read_b32 v20, v14 offset:6912
  ds_read_b32 v21, v14 offset:6916
  ds_read_b32 v22, v14 offset:6920
  v_mov_b32 v19, s20
  s_waitcnt vmcnt(0) lgkmcnt(0)
  v_cmp_ne_u32 vcc, s21, v168
  v_add_f32 v16, v16, v20
  v_add_f32 v17, v17, v21
  v_add_f32 v18, v18, v22
  s_cmp_eq_u64 vcc, 0
  s_cbranch_scc0 L_far_1
  buffer_store_dwordx4 v[16:19], v12, s[16:19], s30 offen
L_back_2:
  s_mul_i32 s28, s4, 49152
  s_add_u32 s28, s28, 524288
  v_mul_u32_u24 v15, 6, v1
  s_mov_b32 s30, 0
  s_mov_b32 s0, 0
  s_sleep 20
L_hq:
  s_add_u32 s29, s28, 4608
  s_add_u32 s31, s28, 9216
  s_mov_b32 s33, 0x80000
L_g_3:
  buffer_load_dwordx4 v[32:35], v12, s[16:19], s28 offen offset:0 sc1 nt
  buffer_load_dwordx4 v[36:39], v12, s[16:19], s28 offen offset:1536 sc1 nt
  buffer_load_dwordx4 v[40:43], v12, s[16:19], s28 offen offset:3072 sc1 nt
  buffer_load_dwordx4 v[44:47], v12, s[16:19], s29 offen offset:0 sc1 nt
  buffer_load_dwordx4 v[48:51], v12, s[16:19], s29 offen offset:1536 sc1 nt
  buffer_load_dwordx4 v[52:55], v12, s[16:19], s29 offen offset:3072 sc1 nt
  buffer_load_dwordx4 v[56:59], v12, s[16:19], s31 offen offset:0 sc1 nt
  buffer_load_dwordx4 v[60:63], v12, s[16:19], s31 offen offset:1536 sc1 nt
  s_waitcnt vmcnt(7)
  v_xor_b32 v3, s20, v35
  s_waitcnt vmcnt(6)
  v_bitop3_b32 v3, v3, s20, v39 bitop3:0xf6
  s_waitcnt vmcnt(5)
  v_bitop3_b32 v3, v3, s20, v43 bitop3:0xf6
  s_waitcnt vmcnt(4)
  v_bitop3_b32 v3, v3, s20, v47 bitop3:0xf6
  s_waitcnt vmcnt(3)
  v_bitop3_b32 v3, v3, s20, v51 bitop3:0xf6
  s_waitcnt vmcnt(2)
  v_bitop3_b32 v3, v3, s20, v55 bitop3:0xf6
  s_waitcnt vmcnt(1)
  v_bitop3_b32 v3, v3, s20, v59 bitop3:0xf6
  s_waitcnt vmcnt(0)
  v_bitop3_b32 v3, v3, s20, v63 bitop3:0xf6
  v_cmp_lt_u32 vcc, 15, v3
  s_nop 0
  s_and_b64 exec, exec, vcc
  s_cbranch_scc0 L_gd_4
  s_sleep 4
  s_sub_u32 s33, s33, 1
  s_cbranch_scc0 L_g_3
L_gd_4:
  s_mov_b64 exec, -1
  v_readfirstlane_b32 s29, v3
  v_pk_add_f32 v[32:33], v[32:33], v[36:37]
  v_add_f32 v34, v34, v38
  v_pk_add_f32 v[40:41], v[40:41], v[44:45]
  v_add_f32 v42, v42, v46
  v_pk_add_f32 v[48:49], v[48:49], v[52:53]
  v_add_f32 v50, v50, v54
  v_pk_add_f32 v[56:57], v[56:57], v[60:61]
  v_add_f32 v58, v58, v62
  v_pk_add_f32 v[32:33], v[32:33], v[40:41]
  v_add_f32 v34, v34, v42
  v_pk_add_f32 v[48:49], v[48:49], v[56:57]
  v_add_f32 v50, v50, v58
  v_pk_add_f32 v[32:33], v[32:33], v[48:49]
  v_add_f32 v34, v34, v50
  s_or_b32 s0, s0, s29
  v_cvt_pk_bf16_f32 v32, v32, v33
  v_cvt_pk_bf16_f32 v34, v34, v34
  s_lshl_b32 s29, s30, 2
  s_lshr_b32 s29, 0x6570, s29
  s_and_b32 s29, s29, 15
  s_mul_i32 s29, s29, 384
  v_add_u32 v2, s29, v15
  s_add_u32 s30, s30, 1
  v_mov_b32 v3, 1
  ds_write_b16 v2, v32 offset:256
  ds_write_b16_d16_hi v2, v32 offset:258
  ds_write_b16 v2, v34 offset:260
  ds_write_b32 v13, v3 offset:0
  s_add_u32 s28, s28, 12288
  s_cmp_lt_u32 s30, 4
  s_waitcnt lgkmcnt(0)
  s_cbranch_scc1 L_hq
  s_setprio 0
  v_mov_b32 v166, 113152
  s_cmp_eq_u32 s5, 31
  s_cbranch_scc0 L_hq_sh
  s_mov_b32 exec_hi, 0
  ds_read_b32 v32, v14 offset:2944
  ds_read_b32 v33, v14 offset:2948
  ds_read_b32 v34, v14 offset:2952
  v_mov_b32 v35, s6
  s_sub_u32 s29, 7, s4
  s_lshr_b32 s31, s29, 1
  s_and_b32 s29, s29, 1
  s_lshl2_add_u32 s29, s29, s31
  s_lshl_b32 s29, s29, 9
  s_add_u32 s29, s29, 32768
  s_waitcnt lgkmcnt(0)
  buffer_store_dwordx4 v[32:35], v12, s[16:19], s29 offen sc1
  s_mov_b64 exec, 1
  buffer_store_byte v13, v13, s[24:27], s23 offen sc1
  s_mov_b64 exec, -1
L_hq_sh:
  s_mov_b32 s33, 0x800000
L_w_5:
  ds_read_b32 v3, v166 offset:0
  s_waitcnt lgkmcnt(0)
  v_readfirstlane_b32 s32, v3
  s_nop 0
  s_cmp_ge_u32 s32, 40
  s_cbranch_scc1 L_d_6
  s_sleep 8
  s_sub_u32 s33, s33, 1
  s_cbranch_scc0 L_w_5
L_d_6:
  s_lshr_b32 s29, s4, 2
  s_lshl_b32 s29, s29, 11
  s_add_u32 s29, s29, 32768
  s_mov_b32 s33, 0x80000
L_g_7:
  buffer_load_dwordx4 v[32:35], v12, s[16:19], s29 offen offset:0 sc1
  buffer_load_dwordx4 v[36:39], v12, s[16:19], s29 offen offset:1024 sc1
  s_waitcnt vmcnt(1)
  v_xor_b32 v3, s6, v35
  s_waitcnt vmcnt(0)
  v_bitop3_b32 v3, v3, s6, v39 bitop3:0xf6
  v_cmp_ne_u32 vcc, 0, v3
  s_nop 0
  s_and_b64 exec, exec, vcc
  s_cbranch_scc0 L_gd_8
  s_sleep 32
  s_sub_u32 s33, s33, 1
  s_cbranch_scc0 L_g_7
L_gd_8:
  s_mov_b64 exec, -1
  ds_write_b32 v14, v32 offset:640
  ds_write_b32 v14, v33 offset:644
  ds_write_b32 v14, v34 offset:648
  ds_write_b32 v14, v36 offset:1408
  ds_write_b32 v14, v37 offset:1412
  ds_write_b32 v14, v38 offset:1416
  v_mov_b32 v3, 2
  ds_write_b32 v13, v3 offset:0
  s_waitcnt lgkmcnt(0)
  v_lshlrev_b32 v15, 9, v9
  v_lshl_add_u32 v15, v10, 4, v15
  v_add_u32 v15, 7680, v15
  v_and_b32 v2, 31, v1
  v_lshlrev_b32 v48, 4, v2
  s_lshl_b32 s28, s4, 9
  s_add_u32 s28, s28, 4096
  s_lshl_b32 s29, s5, 4
  v_mov_b32 v49, s29
  s_mov_b32 s7, 0x3d93cd3a
  s_mov_b32 s21, 0x3fb8aa3b
  s_mov_b32 s22, 0xffff0000
  s_mov_b32 s30, 0
  v_mov_b32 v50, 0
L_hk:
  s_mov_b32 s33, 0x800000
L_w_9:
  ds_read_b32 v3, v50 offset:16
  s_waitcnt lgkmcnt(0)
  v_readfirstlane_b32 s32, v3
  s_nop 0
  s_cmp_ge_u32 s32, 4
  s_cbranch_scc1 L_d_10
  s_sleep 8
  s_sub_u32 s33, s33, 1
  s_cbranch_scc0 L_w_9
L_d_10:
  ds_read_b128 v[16:19], v15 offset:0
  ds_read_b128 v[20:23], v15 offset:4096
  ds_read_b128 v[24:27], v15 offset:8192
  ds_read_b128 v[28:31], v15 offset:12288
  s_waitcnt lgkmcnt(0)
  v_cvt_pk_bf16_f32 v17, v16, v17
  v_lshlrev_b32 v16, 16, v17
  v_and_b32 v17, s22, v17
  v_mul_f32 v16, s7, v16
  v_mul_f32 v17, s7, v17
  v_cvt_pk_bf16_f32 v17, v16, v17
  v_lshlrev_b32 v16, 16, v17
  v_and_b32 v17, s22, v17
  v_cvt_pk_bf16_f32 v19, v18, v19
  v_lshlrev_b32 v18, 16, v19
  v_and_b32 v19, s22, v19
  v_mul_f32 v18, s7, v18
  v_mul_f32 v19, s7, v19
  v_cvt_pk_bf16_f32 v19, v18, v19
  v_lshlrev_b32 v18, 16, v19
  v_and_b32 v19, s22, v19
  v_cvt_pk_bf16_f32 v21, v20, v21
  v_lshlrev_b32 v20, 16, v21
  v_and_b32 v21, s22, v21
  v_mul_f32 v20, s7, v20
  v_mul_f32 v21, s7, v21
  v_cvt_pk_bf16_f32 v21, v20, v21
  v_lshlrev_b32 v20, 16, v21
  v_and_b32 v21, s22, v21
  v_cvt_pk_bf16_f32 v23, v22, v23
  v_lshlrev_b32 v22, 16, v23
  v_and_b32 v23, s22, v23
  v_mul_f32 v22, s7, v22
  v_mul_f32 v23, s7, v23
  v_cvt_pk_bf16_f32 v23, v22, v23
  v_lshlrev_b32 v22, 16, v23
  v_and_b32 v23, s22, v23
  v_cvt_pk_bf16_f32 v25, v24, v25
  v_lshlrev_b32 v24, 16, v25
  v_and_b32 v25, s22, v25
  v_mul_f32 v24, s7, v24
  v_mul_f32 v25, s7, v25
  v_cvt_pk_bf16_f32 v25, v24, v25
  v_lshlrev_b32 v24, 16, v25
  v_and_b32 v25, s22, v25
  v_cvt_pk_bf16_f32 v27, v26, v27
  v_lshlrev_b32 v26, 16, v27
  v_and_b32 v27, s22, v27
  v_mul_f32 v26, s7, v26
  v_mul_f32 v27, s7, v27
  v_cvt_pk_bf16_f32 v27, v26, v27
  v_lshlrev_b32 v26, 16, v27
  v_and_b32 v27, s22, v27
  v_cvt_pk_bf16_f32 v29, v28, v29
  v_lshlrev_b32 v28, 16, v29
  v_and_b32 v29, s22, v29
  v_mul_f32 v28, s7, v28
  v_mul_f32 v29, s7, v29
  v_cvt_pk_bf16_f32 v29, v28, v29
  v_lshlrev_b32 v28, 16, v29
  v_and_b32 v29, s22, v29
  v_cvt_pk_bf16_f32 v31, v30, v31
  v_lshlrev_b32 v30, 16, v31
  v_and_b32 v31, s22, v31
  v_mul_f32 v30, s7, v30
  v_mul_f32 v31, s7, v31
  v_cvt_pk_bf16_f32 v31, v30, v31
  v_lshlrev_b32 v30, 16, v31
  v_and_b32 v31, s22, v31
  v_max_f32 v52, v16, v17
  v_max3_f32 v52, v52, v18, v19
  v_max3_f32 v52, v52, v20, v21
  v_max3_f32 v52, v52, v22, v23
  v_max3_f32 v52, v52, v24, v25
  v_max3_f32 v52, v52, v26, v27
  v_max3_f32 v52, v52, v28, v29
  v_max3_f32 v52, v52, v30, v31
  s_nop 1
  v_max_f32_dpp v52, v52, v52 row_ror:8 row_mask:0xf bank_mask:0xf
  v_mov_b32 v56, v52
  s_nop 1
  v_permlane16_swap_b32 v52, v56
  v_max_f32 v52, v52, v56
  v_mov_b32 v56, v52
  s_nop 1
  v_permlane32_swap_b32 v52, v56
  v_max_f32 v52, v52, v56
  s_nop 1
  v_max_f32_dpp v52, v52, v52 quad_perm:[1,0,3,2] row_mask:0xf bank_mask:0xf
  s_cmp_eq_u32 s30, 1
  s_cbranch_scc1 L_ns_11
  v_max_f32_dpp v52, v52, v52 quad_perm:[2,3,0,1] row_mask:0xf bank_mask:0xf
  s_nop 1
  v_max_f32_dpp v52, v52, v52 row_half_mirror row_mask:0xf bank_mask:0xf
L_ns_11:
  v_max_f32 v52, 0xff7fffff, v52
  v_sub_f32 v32, v16, v52
  v_mul_f32 v32, s21, v32
  v_exp_f32 v32, v32
  v_sub_f32 v33, v17, v52
  v_mul_f32 v33, s21, v33
  v_exp_f32 v33, v33
  v_sub_f32 v34, v18, v52
  v_mul_f32 v34, s21, v34
  v_exp_f32 v34, v34
  v_sub_f32 v35, v19, v52
  v_mul_f32 v35, s21, v35
  v_exp_f32 v35, v35
  v_sub_f32 v36, v20, v52
  v_mul_f32 v36, s21, v36
  v_exp_f32 v36, v36
  v_sub_f32 v37, v21, v52
  v_mul_f32 v37, s21, v37
  v_exp_f32 v37, v37
  v_sub_f32 v38, v22, v52
  v_mul_f32 v38, s21, v38
  v_exp_f32 v38, v38
  v_sub_f32 v39, v23, v52
  v_mul_f32 v39, s21, v39
  v_exp_f32 v39, v39
  v_sub_f32 v40, v24, v52
  v_mul_f32 v40, s21, v40
  v_exp_f32 v40, v40
  v_sub_f32 v41, v25, v52
  v_mul_f32 v41, s21, v41
  v_exp_f32 v41, v41
  v_sub_f32 v42, v26, v52
  v_mul_f32 v42, s21, v42
  v_exp_f32 v42, v42
  v_sub_f32 v43, v27, v52
  v_mul_f32 v43, s21, v43
  v_exp_f32 v43, v43
  v_sub_f32 v44, v28, v52
  v_mul_f32 v44, s21, v44
  v_exp_f32 v44, v44
  v_sub_f32 v45, v29, v52
  v_mul_f32 v45, s21, v45
  v_exp_f32 v45, v45
  v_sub_f32 v46, v30, v52
  v_mul_f32 v46, s21, v46
  v_exp_f32 v46, v46
  v_sub_f32 v47, v31, v52
  v_mul_f32 v47, s21, v47
  v_exp_f32 v47, v47
  v_add_f32 v53, v32, v33
  v_add_f32 v53, v53, v34
  v_add_f32 v53, v53, v35
  v_add_f32 v53, v53, v36
  v_add_f32 v53, v53, v37
  v_add_f32 v53, v53, v38
  v_add_f32 v53, v53, v39
  v_add_f32 v53, v53, v40
  v_add_f32 v53, v53, v41
  v_add_f32 v53, v53, v42
  v_add_f32 v53, v53, v43
  v_add_f32 v53, v53, v44
  v_add_f32 v53, v53, v45
  v_add_f32 v53, v53, v46
  v_add_f32 v53, v53, v47
  s_nop 1
  v_add_f32_dpp v53, v53, v53 row_ror:8 row_mask:0xf bank_mask:0xf
  v_mov_b32 v56, v53
  s_nop 1
  v_permlane16_swap_b32 v53, v56
  v_add_f32 v53, v53, v56
  v_mov_b32 v56, v53
  s_nop 1
  v_permlane32_swap_b32 v53, v56
  v_add_f32 v53, v53, v56
  s_nop 1
  v_add_f32_dpp v53, v53, v53 quad_perm:[1,0,3,2] row_mask:0xf bank_mask:0xf
  s_cmp_eq_u32 s30, 1
  s_cbranch_scc1 L_ns_12
  v_add_f32_dpp v53, v53, v53 quad_perm:[2,3,0,1] row_mask:0xf bank_mask:0xf
  s_nop 1
  v_add_f32_dpp v53, v53, v53 row_half_mirror row_mask:0xf bank_mask:0xf
L_ns_12:
  v_mov_b32 v54, 0
  v_mov_b32 v55, s6
  s_cmp_eq_u32 s30, 1
  s_cbranch_scc1 L_hk_sh
  s_mov_b64 exec, 1
  s_cmp_eq_u32 s0, 0
  s_cbranch_scc0 L_far_13
  buffer_store_dwordx4 v[52:55], v49, s[16:19], s28 offen
L_back_14:
  s_mov_b64 exec, -1
  s_mov_b32 s33, 0x80000
L_g_15:
  buffer_load_dwordx4 v[60:63], v48, s[16:19], s28 offen offset:0 sc1
  s_waitcnt vmcnt(0)
  v_cmp_ne_u32 vcc, s6, v63
  s_nop 0
  s_and_b64 exec, exec, vcc
  s_cbranch_scc0 L_gd_16
  s_sleep 12
  s_sub_u32 s33, s33, 1
  s_cbranch_scc0 L_g_15
L_gd_16:
  s_mov_b64 exec, -1
  v_mov_b32 v64, v60
  s_nop 1
  v_max_f32_dpp v64, v64, v64 quad_perm:[1,0,3,2] row_mask:0xf bank_mask:0xf
  s_nop 1
  v_max_f32_dpp v64, v64, v64 quad_perm:[2,3,0,1] row_mask:0xf bank_mask:0xf
  s_nop 1
  v_max_f32_dpp v64, v64, v64 row_half_mirror row_mask:0xf bank_mask:0xf
  s_nop 1
  v_max_f32_dpp v64, v64, v64 row_mirror row_mask:0xf bank_mask:0xf
  v_mov_b32 v56, v64
  s_nop 1
  v_permlane16_swap_b32 v64, v56
  v_max_f32 v64, v64, v56
  v_sub_f32 v60, v60, v64
  v_mul_f32 v60, s21, v60
  v_exp_f32 v60, v60
  s_nop 0
  v_mul_f32 v61, v61, v60
  s_nop 1
  v_add_f32_dpp v61, v61, v61 quad_perm:[1,0,3,2] row_mask:0xf bank_mask:0xf
  s_nop 1
  v_add_f32_dpp v61, v61, v61 quad_perm:[2,3,0,1] row_mask:0xf bank_mask:0xf
  s_nop 1
  v_add_f32_dpp v61, v61, v61 row_half_mirror row_mask:0xf bank_mask:0xf
  s_nop 1
  v_add_f32_dpp v61, v61, v61 row_mirror row_mask:0xf bank_mask:0xf
  v_mov_b32 v56, v61
  s_nop 1
  v_permlane16_swap_b32 v61, v56
  v_add_f32 v61, v61, v56
  s_branch L_hk_p
L_hk_sh:
  s_lshl_b32 s29, s4, 12
  s_add_u32 s29, s29, 65536
  s_lshl_b32 s31, s5, 7
  s_add_u32 s31, s31, s29
  s_mov_b64 exec, 0xff
  s_cmp_eq_u32 s0, 0
  s_cbranch_scc0 L_far_17
  buffer_store_dwordx4 v[52:55], v12, s[16:19], s31 offen
L_back_18:
  s_mov_b64 exec, -1
  s_cmp_eq_u32 s5, 31
  s_cbranch_scc0 L_hk_sh2
  s_sleep 30
  s_mov_b32 s33, 0x80000
L_g_19:
  buffer_load_dwordx4 v[68:71], v12, s[16:19], s29 offen offset:0 sc1 nt
  buffer_load_dwordx4 v[72:75], v12, s[16:19], s29 offen offset:1024 sc1 nt
  buffer_load_dwordx4 v[76:79], v12, s[16:19], s29 offen offset:2048 sc1 nt
  buffer_load_dwordx4 v[80:83], v12, s[16:19], s29 offen offset:3072 sc1 nt
  s_waitcnt vmcnt(3)
  v_xor_b32 v3, s6, v71
  s_waitcnt vmcnt(2)
  v_bitop3_b32 v3, v3, s6, v75 bitop3:0xf6
  s_waitcnt vmcnt(1)
  v_bitop3_b32 v3, v3, s6, v79 bitop3:0xf6
  s_waitcnt vmcnt(0)
  v_bitop3_b32 v3, v3, s6, v83 bitop3:0xf6
  v_cmp_ne_u32 vcc, 0, v3
  s_nop 0
  s_and_b64 exec, exec, vcc
  s_cbranch_scc0 L_gd_20
  s_sleep 16
  s_sub_u32 s33, s33, 1
  s_cbranch_scc0 L_g_19
L_gd_20:
  s_mov_b64 exec, -1
  v_max3_f32 v52, v68, v72, v76
  v_max_f32 v52, v52, v80
  s_nop 1
  v_max_f32_dpp v52, v52, v52 row_ror:8 row_mask:0xf bank_mask:0xf
  v_mov_b32 v56, v52
  s_nop 1
  v_permlane16_swap_b32 v52, v56
  v_max_f32 v52, v52, v56
  v_mov_b32 v56, v52
  s_nop 1
  v_permlane32_swap_b32 v52, v56
  v_max_f32 v52, v52, v56
  v_sub_f32 v68, v68, v52
  v_mul_f32 v68, s21, v68
  v_exp_f32 v68, v68
  s_nop 0
  v_mul_f32 v69, v69, v68
  v_sub_f32 v72, v72, v52
  v_mul_f32 v72, s21, v72
  v_exp_f32 v72, v72
  s_nop 0
  v_mul_f32 v73, v73, v72
  v_sub_f32 v76, v76, v52
  v_mul_f32 v76, s21, v76
  v_exp_f32 v76, v76
  s_nop 0
  v_mul_f32 v77, v77, v76
  v_sub_f32 v80, v80, v52
  v_mul_f32 v80, s21, v80
  v_exp_f32 v80, v80
  s_nop 0
  v_mul_f32 v81, v81, v80
  v_add_f32 v69, v69, v73
  v_add_f32 v77, v77, v81
  v_add_f32 v53, v69, v77
  s_nop 1
  v_add_f32_dpp v53, v53, v53 row_ror:8 row_mask:0xf bank_mask:0xf
  v_mov_b32 v56, v53
  s_nop 1
  v_permlane16_swap_b32 v53, v56
  v_add_f32 v53, v53, v56
  v_mov_b32 v56, v53
  s_nop 1
  v_permlane32_swap_b32 v53, v56
  v_add_f32 v53, v53, v56
  s_lshl_b32 s31, s4, 7
  s_add_u32 s31, s31, 40960
  s_mov_b64 exec, 0xff
  buffer_store_dwordx4 v[52:55], v12, s[16:19], s31 offen sc1
  s_mov_b64 exec, -1
L_hk_sh2:
  s_mov_b32 s33, 0x800000
L_w_21:
  ds_read_b32 v3, v166 offset:0
  s_waitcnt lgkmcnt(0)
  v_readfirstlane_b32 s32, v3
  s_nop 0
  s_cmp_ge_u32 s32, 232
  s_cbranch_scc1 L_d_22
  s_sleep 8
  s_sub_u32 s33, s33, 1
  s_cbranch_scc0 L_w_21
L_d_22:
  s_lshr_b32 s29, s4, 2
  s_lshl_b32 s29, s29, 9
  s_add_u32 s29, s29, 40960
  s_mov_b32 s33, 0x80000
L_g_23:
  buffer_load_dwordx4 v[60:63], v48, s[16:19], s29 offen offset:0 sc1
  s_waitcnt vmcnt(0)
  v_cmp_ne_u32 vcc, s6, v63
  s_nop 0
  s_and_b64 exec, exec, vcc
  s_cbranch_scc0 L_gd_24
  s_sleep 32
  s_sub_u32 s33, s33, 1
  s_cbranch_scc0 L_g_23
L_gd_24:
  s_mov_b64 exec, -1
  v_mov_b32 v64, v60
  s_nop 1
  v_max_f32_dpp v64, v64, v64 row_ror:8 row_mask:0xf bank_mask:0xf
  v_mov_b32 v56, v64
  s_nop 1
  v_permlane16_swap_b32 v64, v56
  v_max_f32 v64, v64, v56
  v_sub_f32 v60, v60, v64
  v_mul_f32 v60, s21, v60
  v_exp_f32 v60, v60
  s_nop 0
  v_mul_f32 v61, v61, v60
  s_nop 1
  v_add_f32_dpp v61, v61, v61 row_ror:8 row_mask:0xf bank_mask:0xf
  v_mov_b32 v56, v61
  s_nop 1
  v_permlane16_swap_b32 v61, v56
  v_add_f32 v61, v61, v56
L_hk_p:
  v_rcp_f32 v62, v61
  s_nop 0
  v_fma_f32 v63, -v61, v62, 1.0
  v_fma_f32 v62, v63, v62, v62
  v_sub_f32 v32, v16, v64
  v_mul_f32 v32, s21, v32
  v_exp_f32 v32, v32
  v_sub_f32 v33, v17, v64
  v_mul_f32 v33, s21, v33
  v_exp_f32 v33, v33
  v_sub_f32 v34, v18, v64
  v_mul_f32 v34, s21, v34
  v_exp_f32 v34, v34
  v_sub_f32 v35, v19, v64
  v_mul_f32 v35, s21, v35
  v_exp_f32 v35, v35
  v_sub_f32 v36, v20, v64
  v_mul_f32 v36, s21, v36
  v_exp_f32 v36, v36
  v_sub_f32 v37, v21, v64
  v_mul_f32 v37, s21, v37
  v_exp_f32 v37, v37
  v_sub_f32 v38, v22, v64
  v_mul_f32 v38, s21, v38
  v_exp_f32 v38, v38
  v_sub_f32 v39, v23, v64
  v_mul_f32 v39, s21, v39
  v_exp_f32 v39, v39
  v_sub_f32 v40, v24, v64
  v_mul_f32 v40, s21, v40
  v_exp_f32 v40, v40
  v_sub_f32 v41, v25, v64
  v_mul_f32 v41, s21, v41
  v_exp_f32 v41, v41
  v_sub_f32 v42, v26, v64
  v_mul_f32 v42, s21, v42
  v_exp_f32 v42, v42
  v_sub_f32 v43, v27, v64
  v_mul_f32 v43, s21, v43
  v_exp_f32 v43, v43
  v_sub_f32 v44, v28, v64
  v_mul_f32 v44, s21, v44
  v_exp_f32 v44, v44
  v_sub_f32 v45, v29, v64
  v_mul_f32 v45, s21, v45
  v_exp_f32 v45, v45
  v_sub_f32 v46, v30, v64
  v_mul_f32 v46, s21, v46
  v_exp_f32 v46, v46
  v_sub_f32 v47, v31, v64
  v_mul_f32 v47, s21, v47
  v_exp_f32 v47, v47
  v_mul_f32 v32, v32, v62
  v_cvt_pk_bf16_f32 v32, v32, v32
  v_mul_f32 v33, v33, v62
  v_cvt_pk_bf16_f32 v33, v33, v33
  v_mul_f32 v34, v34, v62
  v_cvt_pk_bf16_f32 v34, v34, v34
  v_mul_f32 v35, v35, v62
  v_cvt_pk_bf16_f32 v35, v35, v35
  v_mul_f32 v36, v36, v62
  v_cvt_pk_bf16_f32 v36, v36, v36
  v_mul_f32 v37, v37, v62
  v_cvt_pk_bf16_f32 v37, v37, v37
  v_mul_f32 v38, v38, v62
  v_cvt_pk_bf16_f32 v38, v38, v38
  v_mul_f32 v39, v39, v62
  v_cvt_pk_bf16_f32 v39, v39, v39
  v_mul_f32 v40, v40, v62
  v_cvt_pk_bf16_f32 v40, v40, v40
  v_mul_f32 v41, v41, v62
  v_cvt_pk_bf16_f32 v41, v41, v41
  v_mul_f32 v42, v42, v62
  v_cvt_pk_bf16_f32 v42, v42, v42
  v_mul_f32 v43, v43, v62
  v_cvt_pk_bf16_f32 v43, v43, v43
  v_mul_f32 v44, v44, v62
  v_cvt_pk_bf16_f32 v44, v44, v44
  v_mul_f32 v45, v45, v62
  v_cvt_pk_bf16_f32 v45, v45, v45
  v_mul_f32 v46, v46, v62
  v_cvt_pk_bf16_f32 v46, v46, v46
  v_mul_f32 v47, v47, v62
  v_cvt_pk_bf16_f32 v47, v47, v47
  s_add_u32 s30, s30, 1
  v_mov_b32 v3, s30
  ds_write_b128 v15, v[32:35] offset:0
  ds_write_b128 v15, v[36:39] offset:4096
  ds_write_b128 v15, v[40:43] offset:8192
  ds_write_b128 v15, v[44:47] offset:12288
  ds_write_b32 v13, v3 offset:4
  s_waitcnt lgkmcnt(0)
  v_add_u32 v15, 128, v15
  v_add_u32 v50, 4, v50
  s_add_u32 s28, s28, 4096
  s_cmp_lt_u32 s30, 4
  s_cbranch_scc1 L_hk
  s_and_b32 s28, s5, 15
  s_mul_i32 s28, s28, 40
  v_add_u32 v15, s28, v9
  v_lshlrev_b32 v15, 2, v15
  v_add_u32 v15, 3584, v15
  ds_read_b32 v136, v15 offset:0
  ds_read_b32 v137, v15 offset:32
  ds_read_b32 v138, v15 offset:64
  ds_read_b32 v139, v15 offset:96
  ds_read_b32 v140, v15 offset:128
  v_add_u32 v15, 97792, v12
  ds_read_b128 v[16:19], v15 offset:0
  ds_read_b128 v[20:23], v15 offset:1024
  ds_read_b128 v[24:27], v15 offset:2048
  ds_read_b128 v[28:31], v15 offset:3072
  ds_read_b128 v[32:35], v15 offset:4096
  ds_read_b128 v[36:39], v15 offset:5120
  ds_read_b128 v[40:43], v15 offset:6144
  ds_read_b128 v[44:47], v15 offset:7168
  ds_read_b128 v[48:51], v15 offset:8192
  ds_read_b128 v[52:55], v15 offset:9216
  ds_read_b128 v[56:59], v15 offset:10240
  ds_read_b128 v[60:63], v15 offset:11264
  ds_read_b128 v[64:67], v15 offset:12288
  ds_read_b128 v[68:71], v15 offset:13312
  ds_read_b128 v[72:75], v15 offset:14336
  s_waitcnt lgkmcnt(0)
  v_and_b32 v160, v136, v4
  v_and_b32 v161, v136, v5
  v_and_b32 v162, v136, v6
  v_and_b32 v163, v136, v7
  s_nop 1
  v_mfma_f32_16x16x32_bf16 v[80:83], v[160:163], v[16:19], 0
  v_mfma_f32_16x16x32_bf16 v[84:87], v[160:163], v[20:23], 0
  v_mfma_f32_16x16x32_bf16 v[88:91], v[160:163], v[24:27], 0
  v_and_b32 v164, v137, v4
  v_and_b32 v165, v137, v5
  v_and_b32 v166, v137, v6
  v_and_b32 v167, v137, v7
  s_nop 1
  v_mfma_f32_16x16x32_bf16 v[92:95], v[164:167], v[28:31], 0
  v_mfma_f32_16x16x32_bf16 v[96:99], v[164:167], v[32:35], 0
  v_mfma_f32_16x16x32_bf16 v[100:103], v[164:167], v[36:39], 0
  v_and_b32 v160, v138, v4
  v_and_b32 v161, v138, v5
  v_and_b32 v162, v138, v6
  v_and_b32 v163, v138, v7
  s_nop 1
  v_mfma_f32_16x16x32_bf16 v[104:107], v[160:163], v[40:43], 0
  v_mfma_f32_16x16x32_bf16 v[108:111], v[160:163], v[44:47], 0
  v_mfma_f32_16x16x32_bf16 v[112:115], v[160:163], v[48:51], 0
  v_and_b32 v164, v139, v4
  v_and_b32 v165, v139, v5
  v_and_b32 v166, v139, v6
  v_and_b32 v167, v139, v7
  s_nop 1
  v_mfma_f32_16x16x32_bf16 v[116:119], v[164:167], v[52:55], 0
  v_mfma_f32_16x16x32_bf16 v[120:123], v[164:167], v[56:59], 0
  v_mfma_f32_16x16x32_bf16 v[124:127], v[164:167], v[60:63], 0
  v_and_b32 v160, v140, v4
  v_and_b32 v161, v140, v5
  v_and_b32 v162, v140, v6
  v_and_b32 v163, v140, v7
  s_nop 1
  v_mfma_f32_16x16x32_bf16 v[80:83], v[160:163], v[64:67], v[80:83]
  v_mfma_f32_16x16x32_bf16 v[84:87], v[160:163], v[68:71], v[84:87]
  v_mfma_f32_16x16x32_bf16 v[88:91], v[160:163], v[72:75], v[88:91]
  s_mov_b64 exec, s[34:35]
  ds_write_b128 v11, v[92:95] offset:25600
  ds_write_b128 v11, v[96:99] offset:25856
  ds_write_b128 v11, v[100:103] offset:26112
  ds_write_b128 v11, v[104:107] offset:27136
  ds_write_b128 v11, v[108:111] offset:27392
  ds_write_b128 v11, v[112:115] offset:27648
  ds_write_b128 v11, v[116:119] offset:28672
  ds_write_b128 v11, v[120:123] offset:28928
  ds_write_b128 v11, v[124:127] offset:29184
  ds_write_b128 v11, v[80:83] offset:24064
  ds_write_b128 v11, v[84:87] offset:24320
  ds_write_b128 v11, v[88:91] offset:24576
  s_mov_b64 exec, -1
  v_add_u32 v14, 24064, v12
  v_lshlrev_b32 v15, 2, v1
  v_add_u32 v15, 73216, v15
  v_lshlrev_b32 v145, 5, v1
  v_lshlrev_b32 v165, 3, v1
  v_and_b32 v2, 31, v1
  v_lshlrev_b32 v160, 4, v2
  s_lshl_b32 s29, s5, 4
  v_mov_b32 v161, s29
  s_lshl_b32 s71, s4, 9
  s_add_u32 s71, s71, 4096
  v_lshrrev_b32 v2, 4, v1
  v_and_b32 v3, 15, v1
  v_lshlrev_b32 v164, 3, v3
  v_mul_u32_u24 v146, 1536, v2
  v_lshl_add_u32 v146, v3, 4, v146
  v_lshrrev_b32 v2, 2, v1
  v_and_b32 v3, 3, v1
  v_lshlrev_b32 v147, 11, v2
  v_lshl_add_u32 v147, v3, 4, v147
  s_lshr_b32 s22, s5, 3
  s_lshl3_add_u32 s22, s22, s4
  s_and_b32 s29, s5, 7
  s_lshl3_add_u32 s78, s22, s29
  s_lshl_b32 s22, s78, 4
  v_lshl_add_u32 v148, v3, 2, s22
  buffer_load_dword v149, v148, s[8:11], 0 offen
  s_mov_b64 s[12:13], s[54:55]
  s_mov_b32 s14, 1280
  s_mov_b32 s15, 0x20000
  s_mul_hi_u32 s24, s5, 0x33333334
  s_mul_i32 s25, s24, 5
  s_sub_u32 s25, s5, s25
  s_min_u32 s24, s24, 5
  s_lshl_b32 s28, s4, 5
  s_add_u32 s31, s28, s5
  s_mul_i32 s31, s31, 1536
  s_add_u32 s31, s31, 524288
  s_mul_i32 s28, s28, 1536
  s_lshl_b32 s29, s24, 8
  s_add_u32 s28, s28, s29
  s_add_u32 s28, s28, 524288
  s_mul_i32 s23, s25, 48
  s_mul_i32 s29, s4, 6
  s_add_u32 s23, s23, s29
  s_add_u32 s23, s23, s24
  s_lshl_b32 s23, s23, 11
  s_add_u32 s23, s23, 1048576
  s_lshr_b32 s22, s78, 4
  s_mul_i32 s22, s22, 98304
  s_and_b32 s29, s78, 15
  s_lshl_b32 s29, s29, 6
  s_add_u32 s22, s22, s29
  s_add_u32 s68, s22, 1048576
  s_add_u32 s69, s22, 1081344
  s_add_u32 s70, s22, 1114112
  s_mov_b32 s20, 0x05040100
  s_mov_b32 s21, 0x07060302
  s_mov_b32 s30, 0
  v_mov_b32 v150, 0
  v_mov_b32 v136, 0
  v_mov_b32 v137, 0
  v_mov_b32 v138, 0
  v_mov_b32 v139, 0
  v_mov_b32 v142, s6
  v_mov_b32 v143, s6
  v_mov_b32 v158, s6
  v_mov_b32 v159, s6
  s_lshl_b32 s72, 4, s25
  s_or_b32 s72, s72, 0x43
  s_cmp_lt_u32 s5, 30
  s_cselect_b32 s72, s72, 0
  s_lshr_b32 s29, s4, 2
  s_lshl1_add_u32 s29, s25, s29
  s_sub_u32 s75, 7, s29
  s_mul_i32 s73, s75, 6
  s_add_u32 s73, s73, s24
  s_and_b32 s29, s4, 3
  s_lshl2_add_u32 s73, s73, s29
  s_lshl_b32 s73, s73, 8
  s_add_u32 s73, s73, 131072
  s_mul_i32 s74, s4, 6
  s_add_u32 s74, s74, s24
  s_lshl_b32 s74, s74, 10
  s_add_u32 s74, s74, 131072
  s_add_u32 s60, s28, 0
  s_add_u32 s61, s28, 6144
  s_add_u32 s62, s28, 12288
  s_add_u32 s63, s28, 18432
  s_add_u32 s64, s28, 24576
  s_add_u32 s65, s28, 30720
  s_add_u32 s66, s28, 36864
  s_add_u32 s67, s28, 43008
L_hc:
  s_or_b32 s1, s6, s30
  s_bitset1_b32 s1, 4
  s_waitcnt lgkmcnt(0)
  v_mov_b32 v114, s1
  v_mov_b32 v115, s1
  v_mov_b32 v118, s1
  v_mov_b32 v119, s1
  s_bitcmp1_b32 0x181, s30
  s_cbranch_scc0 L_hc_wait
  ds_read2st64_b32 v[16:17], v15 offset0:0 offset1:1
  ds_read2st64_b32 v[18:19], v15 offset0:2 offset1:3
  ds_read2st64_b32 v[20:21], v15 offset0:4 offset1:5
  ds_read2st64_b32 v[22:23], v15 offset0:6 offset1:7
  ds_read2st64_b32 v[24:25], v15 offset0:8 offset1:9
  ds_read2st64_b32 v[26:27], v15 offset0:10 offset1:11
  ds_read2st64_b32 v[28:29], v15 offset0:12 offset1:13
  ds_read2st64_b32 v[30:31], v15 offset0:14 offset1:15
  ds_read2st64_b32 v[32:33], v15 offset0:16 offset1:17
  ds_read2st64_b32 v[34:35], v15 offset0:18 offset1:19
  ds_read2st64_b32 v[36:37], v15 offset0:20 offset1:21
  ds_read2st64_b32 v[38:39], v15 offset0:22 offset1:23
  ds_read2st64_b32 v[40:41], v15 offset0:24 offset1:25
  ds_read2st64_b32 v[42:43], v15 offset0:26 offset1:27
  ds_read2st64_b32 v[44:45], v15 offset0:28 offset1:29
  ds_read2st64_b32 v[46:47], v15 offset0:30 offset1:31
  s_waitcnt lgkmcnt(0)
  v_perm_b32 v48, v17, v16, s20
  v_perm_b32 v49, v17, v16, s21
  v_perm_b32 v50, v19, v18, s20
  v_perm_b32 v51, v19, v18, s21
  v_perm_b32 v52, v21, v20, s20
  v_perm_b32 v53, v21, v20, s21
  v_perm_b32 v54, v23, v22, s20
  v_perm_b32 v55, v23, v22, s21
  v_perm_b32 v56, v25, v24, s20
  v_perm_b32 v57, v25, v24, s21
  v_perm_b32 v58, v27, v26, s20
  v_perm_b32 v59, v27, v26, s21
  v_perm_b32 v60, v29, v28, s20
  v_perm_b32 v61, v29, v28, s21
  v_perm_b32 v62, v31, v30, s20
  v_perm_b32 v63, v31, v30, s21
  v_perm_b32 v64, v33, v32, s20
  v_perm_b32 v65, v33, v32, s21
  v_perm_b32 v66, v35, v34, s20
  v_perm_b32 v67, v35, v34, s21
  v_perm_b32 v68, v37, v36, s20
  v_perm_b32 v69, v37, v36, s21
  v_perm_b32 v70, v39, v38, s20
  v_perm_b32 v71, v39, v38, s21
  v_perm_b32 v72, v41, v40, s20
  v_perm_b32 v73, v41, v40, s21
  v_perm_b32 v74, v43, v42, s20
  v_perm_b32 v75, v43, v42, s21
  v_perm_b32 v76, v45, v44, s20
  v_perm_b32 v77, v45, v44, s21
  v_perm_b32 v78, v47, v46, s20
  v_perm_b32 v79, v47, v46, s21
  v_add_u32 v15, 8192, v15
  s_cmp_eq_u32 s30, 8
  s_cbranch_scc1 L_tail
  s_cmp_eq_u32 s30, 7
  s_cbranch_scc1 L_hc_fin
  s_branch L_hc_go
L_hc_wait:
  s_mov_b32 s33, 0x800000
L_w_25:
  ds_read_b32 v3, v150 offset:28
  s_waitcnt lgkmcnt(0)
  v_readfirstlane_b32 s32, v3
  s_nop 0
  s_cmp_ge_u32 s32, 4
  s_cbranch_scc1 L_d_26
  s_sleep 4
  s_sub_u32 s33, s33, 1
  s_cbranch_scc0 L_w_25
L_d_26:
L_hc_go:
  s_mov_b32 exec_hi, 0xffff
  ds_read_b128 v[80:83], v14 offset:0
  ds_read_b128 v[84:87], v14 offset:768
  ds_read_b128 v[88:91], v14 offset:1536
  ds_read_b128 v[92:95], v14 offset:2304
  ds_read_b128 v[96:99], v14 offset:3072
  ds_read_b128 v[100:103], v14 offset:3840
  ds_read_b128 v[104:107], v14 offset:4608
  ds_read_b128 v[108:111], v14 offset:5376
  s_cmp_eq_u32 s0, 0
  s_waitcnt lgkmcnt(6)
  v_pk_add_f32 v[80:81], v[80:81], v[84:85]
  v_pk_add_f32 v[82:83], v[82:83], v[86:87]
  s_waitcnt lgkmcnt(4)
  v_pk_add_f32 v[88:89], v[88:89], v[92:93]
  v_pk_add_f32 v[90:91], v[90:91], v[94:95]
  v_pk_add_f32 v[80:81], v[80:81], v[88:89]
  v_pk_add_f32 v[82:83], v[82:83], v[90:91]
  s_waitcnt lgkmcnt(2)
  v_pk_add_f32 v[96:97], v[96:97], v[100:101]
  v_pk_add_f32 v[98:99], v[98:99], v[102:103]
  s_waitcnt lgkmcnt(0)
  v_pk_add_f32 v[104:105], v[104:105], v[108:109]
  v_pk_add_f32 v[106:107], v[106:107], v[110:111]
  v_pk_add_f32 v[96:97], v[96:97], v[104:105]
  v_pk_add_f32 v[98:99], v[98:99], v[106:107]
  v_pk_add_f32 v[112:113], v[80:81], v[96:97]
  v_pk_add_f32 v[116:117], v[82:83], v[98:99]
  s_cbranch_scc0 L_far_27
  buffer_store_dwordx4 v[112:115], v145, s[16:19], s31 offen
  buffer_store_dwordx4 v[116:119], v145, s[16:19], s31 offen offset:16
L_back_28:
  s_mov_b64 exec, -1
  s_bitcmp1_b32 s72, s30
  s_cbranch_scc0 L_hc_ack
  s_sleep 16
  s_mov_b32 s33, 0x80000
L_g_29:
  buffer_load_dwordx4 v[80:83], v146, s[16:19], s60 offen offset:0 sc1 nt
  buffer_load_dwordx4 v[84:87], v146, s[16:19], s61 offen offset:0 sc1 nt
  buffer_load_dwordx4 v[88:91], v146, s[16:19], s62 offen offset:0 sc1 nt
  buffer_load_dwordx4 v[92:95], v146, s[16:19], s63 offen offset:0 sc1 nt
  buffer_load_dwordx4 v[96:99], v146, s[16:19], s64 offen offset:0 sc1 nt
  buffer_load_dwordx4 v[100:103], v146, s[16:19], s65 offen offset:0 sc1 nt
  buffer_load_dwordx4 v[104:107], v146, s[16:19], s66 offen offset:0 sc1 nt
  buffer_load_dwordx4 v[108:111], v146, s[16:19], s67 offen offset:0 sc1 nt
  s_waitcnt vmcnt(7)
  v_xor_b32 v3, s1, v83
  s_waitcnt vmcnt(6)
  v_bitop3_b32 v3, v3, s1, v87 bitop3:0xf6
  s_waitcnt vmcnt(5)
  v_bitop3_b32 v3, v3, s1, v91 bitop3:0xf6
  s_waitcnt vmcnt(4)
  v_bitop3_b32 v3, v3, s1, v95 bitop3:0xf6
  s_waitcnt vmcnt(3)
  v_bitop3_b32 v3, v3, s1, v99 bitop3:0xf6
  s_waitcnt vmcnt(2)
  v_bitop3_b32 v3, v3, s1, v103 bitop3:0xf6
  s_waitcnt vmcnt(1)
  v_bitop3_b32 v3, v3, s1, v107 bitop3:0xf6
  s_waitcnt vmcnt(0)
  v_bitop3_b32 v3, v3, s1, v111 bitop3:0xf6
  v_cmp_ne_u32 vcc, 0, v3
  s_nop 0
  s_and_b64 exec, exec, vcc
  s_cbranch_scc0 L_gd_30
  s_sleep 12
  s_sub_u32 s33, s33, 1
  s_cbranch_scc0 L_g_29
L_gd_30:
  s_mov_b64 exec, -1
L_hc_ack:
  s_mov_b64 exec, 1
  s_cmp_eq_u32 s0, 0
  s_cbranch_scc0 L_far_31
  buffer_store_dwordx4 v[112:115], v161, s[16:19], s71 offen
L_back_32:
  s_mov_b64 exec, -1
  s_bitcmp1_b32 s72, s30
  s_cbranch_scc0 L_hc_next
  v_pk_add_f32 v[80:81], v[80:81], v[84:85]
  v_pk_add_f32 v[88:89], v[88:89], v[92:93]
  v_pk_add_f32 v[96:97], v[96:97], v[100:101]
  v_pk_add_f32 v[104:105], v[104:105], v[108:109]
  v_pk_add_f32 v[80:81], v[80:81], v[88:89]
  v_pk_add_f32 v[96:97], v[96:97], v[104:105]
  s_cmp_eq_u32 s30, 0
  s_cbranch_scc0 L_hc_att
  v_mov_b32 v84, v80
  v_mov_b32 v85, v81
  v_mov_b32 v86, v96
  v_mov_b32 v87, v97
  v_permlane16_swap_b32 v80, v84
  v_permlane16_swap_b32 v81, v85
  v_permlane16_swap_b32 v96, v86
  v_permlane16_swap_b32 v97, v87
  v_add_f32 v80, v80, v84
  v_add_f32 v81, v81, v85
  v_add_f32 v96, v96, v86
  v_add_f32 v97, v97, v87
  v_mov_b32 v84, v80
  v_mov_b32 v85, v81
  v_mov_b32 v86, v96
  v_mov_b32 v87, v97
  v_permlane32_swap_b32 v80, v84
  v_permlane32_swap_b32 v81, v85
  v_permlane32_swap_b32 v96, v86
  v_permlane32_swap_b32 v97, v87
  v_add_f32 v80, v80, v84
  v_add_f32 v81, v81, v85
  v_add_f32 v96, v96, v86
  v_add_f32 v97, v97, v87
  v_cvt_pk_bf16_f32 v96, v80, v96
  v_lshlrev_b32 v80, 16, v96
  v_and_b32 v96, 0xffff0000, v96
  v_cmp_lt_f32 vcc, 0, v80
  s_nop 1
  v_cndmask_b32 v84, 0, 1.0, vcc
  v_mul_f32 v80, v80, v84
  v_mul_f32 v80, v80, v96
  v_cvt_pk_bf16_f32 v97, v81, v97
  v_lshlrev_b32 v81, 16, v97
  v_and_b32 v97, 0xffff0000, v97
  v_cmp_lt_f32 vcc, 0, v81
  s_nop 1
  v_cndmask_b32 v84, 0, 1.0, vcc
  v_mul_f32 v81, v81, v84
  v_mul_f32 v81, v81, v97
  s_branch L_hc_pack
L_hc_att:
  v_pk_add_f32 v[80:81], v[80:81], v[96:97]
  v_mov_b32 v84, v80
  v_mov_b32 v85, v81
  s_nop 0
  v_permlane16_swap_b32 v80, v84
  v_permlane16_swap_b32 v81, v85
  v_add_f32 v80, v80, v84
  v_add_f32 v81, v81, v85
  v_mov_b32 v84, v80
  v_mov_b32 v85, v81
  s_nop 0
  v_permlane32_swap_b32 v80, v84
  v_permlane32_swap_b32 v81, v85
  v_add_f32 v80, v80, v84
  v_add_f32 v81, v81, v85
  s_bitcmp1_b32 0x42, s30
  s_cbranch_scc0 L_hc_sh
  v_cvt_pk_bf16_f32 v80, v80, v80
  v_cvt_pk_bf16_f32 v81, v81, v81
  ds_write_b64 v164, v[80:81] offset:3328
  v_add_u32 v164, 128, v164
  s_branch L_hc_next
L_hc_sh:
  v_mov_b32 v82, s6
  v_mov_b32 v83, s6
  s_mov_b64 exec, 0xffff
  buffer_store_dwordx4 v[80:83], v12, s[16:19], s73 offen sc1
  s_mov_b64 exec, -1
  s_branch L_hc_next
L_hc_fin:
  s_add_u32 s30, s30, 1
  s_cmp_ge_u32 s5, 30
  s_cbranch_scc1 L_hc
  s_mov_b32 s33, 0x80000
L_g_33:
  buffer_load_dwordx4 v[80:83], v12, s[16:19], s74 offen offset:0 sc1
  s_waitcnt vmcnt(0)
  v_cmp_ne_u32 vcc, s6, v83
  s_nop 0
  s_and_b64 exec, exec, vcc
  s_cbranch_scc0 L_gd_34
  s_sleep 32
  s_sub_u32 s33, s33, 1
  s_cbranch_scc0 L_g_33
L_gd_34:
  s_mov_b64 exec, -1
  v_mov_b32 v84, v80
  v_mov_b32 v85, v81
  s_nop 0
  v_permlane16_swap_b32 v80, v84
  v_permlane16_swap_b32 v81, v85
  v_add_f32 v80, v80, v84
  v_add_f32 v81, v81, v85
  v_mov_b32 v84, v80
  v_mov_b32 v85, v81
  s_nop 0
  v_permlane32_swap_b32 v80, v84
  v_permlane32_swap_b32 v81, v85
  v_add_f32 v80, v80, v84
  v_add_f32 v81, v81, v85
L_hc_pack:
  v_cvt_pk_bf16_f32 v80, v80, v81
  s_nop 1
  v_dot2c_f32_bf16_dpp v136, v80, v48 row_newbcast:0 row_mask:0xf bank_mask:0xf
  v_dot2c_f32_bf16_dpp v137, v80, v49 row_newbcast:0 row_mask:0xf bank_mask:0xf
  v_dot2c_f32_bf16_dpp v138, v80, v50 row_newbcast:1 row_mask:0xf bank_mask:0xf
  v_dot2c_f32_bf16_dpp v139, v80, v51 row_newbcast:1 row_mask:0xf bank_mask:0xf
  v_dot2c_f32_bf16_dpp v136, v80, v52 row_newbcast:2 row_mask:0xf bank_mask:0xf
  v_dot2c_f32_bf16_dpp v137, v80, v53 row_newbcast:2 row_mask:0xf bank_mask:0xf
  v_dot2c_f32_bf16_dpp v138, v80, v54 row_newbcast:3 row_mask:0xf bank_mask:0xf
  v_dot2c_f32_bf16_dpp v139, v80, v55 row_newbcast:3 row_mask:0xf bank_mask:0xf
  v_dot2c_f32_bf16_dpp v136, v80, v56 row_newbcast:4 row_mask:0xf bank_mask:0xf
  v_dot2c_f32_bf16_dpp v137, v80, v57 row_newbcast:4 row_mask:0xf bank_mask:0xf
  v_dot2c_f32_bf16_dpp v138, v80, v58 row_newbcast:5 row_mask:0xf bank_mask:0xf
  v_dot2c_f32_bf16_dpp v139, v80, v59 row_newbcast:5 row_mask:0xf bank_mask:0xf
  v_dot2c_f32_bf16_dpp v136, v80, v60 row_newbcast:6 row_mask:0xf bank_mask:0xf
  v_dot2c_f32_bf16_dpp v137, v80, v61 row_newbcast:6 row_mask:0xf bank_mask:0xf
  v_dot2c_f32_bf16_dpp v138, v80, v62 row_newbcast:7 row_mask:0xf bank_mask:0xf
  v_dot2c_f32_bf16_dpp v139, v80, v63 row_newbcast:7 row_mask:0xf bank_mask:0xf
  v_dot2c_f32_bf16_dpp v136, v80, v64 row_newbcast:8 row_mask:0xf bank_mask:0xf
  v_dot2c_f32_bf16_dpp v137, v80, v65 row_newbcast:8 row_mask:0xf bank_mask:0xf
  v_dot2c_f32_bf16_dpp v138, v80, v66 row_newbcast:9 row_mask:0xf bank_mask:0xf
  v_dot2c_f32_bf16_dpp v139, v80, v67 row_newbcast:9 row_mask:0xf bank_mask:0xf
  v_dot2c_f32_bf16_dpp v136, v80, v68 row_newbcast:10 row_mask:0xf bank_mask:0xf
  v_dot2c_f32_bf16_dpp v137, v80, v69 row_newbcast:10 row_mask:0xf bank_mask:0xf
  v_dot2c_f32_bf16_dpp v138, v80, v70 row_newbcast:11 row_mask:0xf bank_mask:0xf
  v_dot2c_f32_bf16_dpp v139, v80, v71 row_newbcast:11 row_mask:0xf bank_mask:0xf
  v_dot2c_f32_bf16_dpp v136, v80, v72 row_newbcast:12 row_mask:0xf bank_mask:0xf
  v_dot2c_f32_bf16_dpp v137, v80, v73 row_newbcast:12 row_mask:0xf bank_mask:0xf
  v_dot2c_f32_bf16_dpp v138, v80, v74 row_newbcast:13 row_mask:0xf bank_mask:0xf
  v_dot2c_f32_bf16_dpp v139, v80, v75 row_newbcast:13 row_mask:0xf bank_mask:0xf
  v_dot2c_f32_bf16_dpp v136, v80, v76 row_newbcast:14 row_mask:0xf bank_mask:0xf
  v_dot2c_f32_bf16_dpp v137, v80, v77 row_newbcast:14 row_mask:0xf bank_mask:0xf
  v_dot2c_f32_bf16_dpp v138, v80, v78 row_newbcast:15 row_mask:0xf bank_mask:0xf
  v_dot2c_f32_bf16_dpp v139, v80, v79 row_newbcast:15 row_mask:0xf bank_mask:0xf
  s_cmp_eq_u32 s30, 0
  s_cbranch_scc0 L_hc
  s_nop 0
  v_pk_add_f32 v[156:157], v[136:137], v[138:139]
  v_mov_b32 v136, 0
  v_mov_b32 v137, 0
  v_mov_b32 v138, 0
  v_mov_b32 v139, 0
  v_lshlrev_b32 v152, 16, v149
  v_and_b32 v153, 0xffff0000, v149
L_hc_next:
  v_add_u32 v14, 6144, v14
  v_add_u32 v150, 4, v150
  s_sleep 30
  s_mov_b32 s33, 0x80000
L_g_35:
  buffer_load_dwordx4 v[120:123], v160, s[16:19], s71 offen offset:0 sc1
  s_waitcnt vmcnt(0)
  v_subrev_u32 v3, s1, v123
  v_cmp_lt_u32 vcc, 1, v3
  s_nop 0
  s_and_b64 exec, exec, vcc
  s_cbranch_scc0 L_gd_36
  s_sleep 12
  s_sub_u32 s33, s33, 1
  s_cbranch_scc0 L_g_35
L_gd_36:
  s_mov_b64 exec, -1
  s_add_u32 s30, s30, 1
  s_branch L_hc
L_tail:
  s_cmp_eq_u32 s2, 0
  s_cbranch_scc0 L_tail2
  s_mov_b64 exec, 1
  v_mov_b32 v3, s77
  buffer_store_dword v3, v13, s[16:19], 0 offen sc1
  s_mov_b64 exec, -1
L_tail2:
  s_setprio 2
  s_barrier
  s_mov_b32 exec_hi, 0xffff
  ds_read_b128 v[80:83], v14 offset:0
  ds_read_b128 v[84:87], v14 offset:768
  ds_read_b128 v[88:91], v14 offset:1536
  ds_read_b128 v[92:95], v14 offset:2304
  ds_read_b128 v[96:99], v14 offset:3072
  ds_read_b128 v[100:103], v14 offset:3840
  ds_read_b128 v[104:107], v14 offset:4608
  ds_read_b128 v[108:111], v14 offset:5376
  s_cmp_eq_u32 s0, 0
  s_waitcnt lgkmcnt(6)
  v_pk_add_f32 v[80:81], v[80:81], v[84:85]
  v_pk_add_f32 v[82:83], v[82:83], v[86:87]
  s_waitcnt lgkmcnt(4)
  v_pk_add_f32 v[88:89], v[88:89], v[92:93]
  v_pk_add_f32 v[90:91], v[90:91], v[94:95]
  v_pk_add_f32 v[80:81], v[80:81], v[88:89]
  v_pk_add_f32 v[82:83], v[82:83], v[90:91]
  s_waitcnt lgkmcnt(2)
  v_pk_add_f32 v[96:97], v[96:97], v[100:101]
  v_pk_add_f32 v[98:99], v[98:99], v[102:103]
  s_waitcnt lgkmcnt(0)
  v_pk_add_f32 v[104:105], v[104:105], v[108:109]
  v_pk_add_f32 v[106:107], v[106:107], v[110:111]
  v_pk_add_f32 v[96:97], v[96:97], v[104:105]
  v_pk_add_f32 v[98:99], v[98:99], v[106:107]
  v_pk_add_f32 v[112:113], v[80:81], v[96:97]
  v_pk_add_f32 v[116:117], v[82:83], v[98:99]
  s_cbranch_scc0 L_far_37
  buffer_store_dwordx4 v[112:115], v145, s[16:19], s31 offen
  buffer_store_dwordx4 v[116:119], v145, s[16:19], s31 offen offset:16
L_back_38:
  s_mov_b64 exec, -1
  s_cmp_ge_u32 s5, 30
  s_cbranch_scc1 L_hfin
  s_mov_b32 s33, 0x80000
L_g_39:
  buffer_load_dwordx4 v[16:19], v146, s[16:19], s60 offen offset:0 sc1 nt
  buffer_load_dwordx4 v[20:23], v146, s[16:19], s61 offen offset:0 sc1 nt
  buffer_load_dwordx4 v[24:27], v146, s[16:19], s62 offen offset:0 sc1 nt
  buffer_load_dwordx4 v[28:31], v146, s[16:19], s63 offen offset:0 sc1 nt
  buffer_load_dwordx4 v[32:35], v146, s[16:19], s64 offen offset:0 sc1 nt
  buffer_load_dwordx4 v[36:39], v146, s[16:19], s65 offen offset:0 sc1 nt
  buffer_load_dwordx4 v[40:43], v146, s[16:19], s66 offen offset:0 sc1 nt
  buffer_load_dwordx4 v[44:47], v146, s[16:19], s67 offen offset:0 sc1 nt
  s_waitcnt vmcnt(7)
  v_xor_b32 v3, s1, v19
  s_waitcnt vmcnt(6)
  v_bitop3_b32 v3, v3, s1, v23 bitop3:0xf6
  s_waitcnt vmcnt(5)
  v_bitop3_b32 v3, v3, s1, v27 bitop3:0xf6
  s_waitcnt vmcnt(4)
  v_bitop3_b32 v3, v3, s1, v31 bitop3:0xf6
  s_waitcnt vmcnt(3)
  v_bitop3_b32 v3, v3, s1, v35 bitop3:0xf6
  s_waitcnt vmcnt(2)
  v_bitop3_b32 v3, v3, s1, v39 bitop3:0xf6
  s_waitcnt vmcnt(1)
  v_bitop3_b32 v3, v3, s1, v43 bitop3:0xf6
  s_waitcnt vmcnt(0)
  v_bitop3_b32 v3, v3, s1, v47 bitop3:0xf6
  v_cmp_ne_u32 vcc, 0, v3
  s_nop 0
  s_and_b64 exec, exec, vcc
  s_cbranch_scc0 L_gd_40
  s_sub_u32 s33, s33, 1
  s_cbranch_scc0 L_g_39
L_gd_40:
  s_mov_b64 exec, -1
  buffer_store_dwordx4 v[156:159], v12, s[16:19], s23 offen offset:1024 sc1
  s_barrier
  ds_read_b64 v[120:121], v165 offset:24064
  ds_read_b64 v[122:123], v165 offset:24832
  ds_read_b64 v[124:125], v165 offset:25600
  ds_read_b64 v[126:127], v165 offset:26368
  ds_read_b64 v[128:129], v165 offset:27136
  ds_read_b64 v[130:131], v165 offset:27904
  ds_read_b64 v[132:133], v165 offset:28672
  ds_read_b64 v[134:135], v165 offset:29440
  v_pk_add_f32 v[80:81], v[16:17], v[20:21]
  v_pk_add_f32 v[88:89], v[24:25], v[28:29]
  v_pk_add_f32 v[96:97], v[32:33], v[36:37]
  v_pk_add_f32 v[104:105], v[40:41], v[44:45]
  v_pk_add_f32 v[80:81], v[80:81], v[88:89]
  v_pk_add_f32 v[96:97], v[96:97], v[104:105]
  v_pk_add_f32 v[80:81], v[80:81], v[96:97]
  v_mov_b32 v84, v80
  v_mov_b32 v85, v81
  s_nop 0
  v_permlane16_swap_b32 v80, v84
  v_permlane16_swap_b32 v81, v85
  v_add_f32 v80, v80, v84
  v_add_f32 v81, v81, v85
  v_mov_b32 v84, v80
  v_mov_b32 v85, v81
  s_nop 0
  v_permlane32_swap_b32 v80, v84
  v_permlane32_swap_b32 v81, v85
  v_add_f32 v80, v80, v84
  v_add_f32 v81, v81, v85
  v_cvt_pk_bf16_f32 v80, v80, v81
  s_nop 1
  v_dot2c_f32_bf16_dpp v136, v80, v48 row_newbcast:0 row_mask:0xf bank_mask:0xf
  v_dot2c_f32_bf16_dpp v137, v80, v49 row_newbcast:0 row_mask:0xf bank_mask:0xf
  v_dot2c_f32_bf16_dpp v138, v80, v50 row_newbcast:1 row_mask:0xf bank_mask:0xf
  v_dot2c_f32_bf16_dpp v139, v80, v51 row_newbcast:1 row_mask:0xf bank_mask:0xf
  v_dot2c_f32_bf16_dpp v136, v80, v52 row_newbcast:2 row_mask:0xf bank_mask:0xf
  v_dot2c_f32_bf16_dpp v137, v80, v53 row_newbcast:2 row_mask:0xf bank_mask:0xf
  v_dot2c_f32_bf16_dpp v138, v80, v54 row_newbcast:3 row_mask:0xf bank_mask:0xf
  v_dot2c_f32_bf16_dpp v139, v80, v55 row_newbcast:3 row_mask:0xf bank_mask:0xf
  v_dot2c_f32_bf16_dpp v136, v80, v56 row_newbcast:4 row_mask:0xf bank_mask:0xf
  v_dot2c_f32_bf16_dpp v137, v80, v57 row_newbcast:4 row_mask:0xf bank_mask:0xf
  v_dot2c_f32_bf16_dpp v138, v80, v58 row_newbcast:5 row_mask:0xf bank_mask:0xf
  v_dot2c_f32_bf16_dpp v139, v80, v59 row_newbcast:5 row_mask:0xf bank_mask:0xf
  v_dot2c_f32_bf16_dpp v136, v80, v60 row_newbcast:6 row_mask:0xf bank_mask:0xf
  v_dot2c_f32_bf16_dpp v137, v80, v61 row_newbcast:6 row_mask:0xf bank_mask:0xf
  v_dot2c_f32_bf16_dpp v138, v80, v62 row_newbcast:7 row_mask:0xf bank_mask:0xf
  v_dot2c_f32_bf16_dpp v139, v80, v63 row_newbcast:7 row_mask:0xf bank_mask:0xf
  v_dot2c_f32_bf16_dpp v136, v80, v64 row_newbcast:8 row_mask:0xf bank_mask:0xf
  v_dot2c_f32_bf16_dpp v137, v80, v65 row_newbcast:8 row_mask:0xf bank_mask:0xf
  v_dot2c_f32_bf16_dpp v138, v80, v66 row_newbcast:9 row_mask:0xf bank_mask:0xf
  v_dot2c_f32_bf16_dpp v139, v80, v67 row_newbcast:9 row_mask:0xf bank_mask:0xf
  v_dot2c_f32_bf16_dpp v136, v80, v68 row_newbcast:10 row_mask:0xf bank_mask:0xf
  v_dot2c_f32_bf16_dpp v137, v80, v69 row_newbcast:10 row_mask:0xf bank_mask:0xf
  v_dot2c_f32_bf16_dpp v138, v80, v70 row_newbcast:11 row_mask:0xf bank_mask:0xf
  v_dot2c_f32_bf16_dpp v139, v80, v71 row_newbcast:11 row_mask:0xf bank_mask:0xf
  v_dot2c_f32_bf16_dpp v136, v80, v72 row_newbcast:12 row_mask:0xf bank_mask:0xf
  v_dot2c_f32_bf16_dpp v137, v80, v73 row_newbcast:12 row_mask:0xf bank_mask:0xf
  v_dot2c_f32_bf16_dpp v138, v80, v74 row_newbcast:13 row_mask:0xf bank_mask:0xf
  v_dot2c_f32_bf16_dpp v139, v80, v75 row_newbcast:13 row_mask:0xf bank_mask:0xf
  v_dot2c_f32_bf16_dpp v136, v80, v76 row_newbcast:14 row_mask:0xf bank_mask:0xf
  v_dot2c_f32_bf16_dpp v137, v80, v77 row_newbcast:14 row_mask:0xf bank_mask:0xf
  v_dot2c_f32_bf16_dpp v138, v80, v78 row_newbcast:15 row_mask:0xf bank_mask:0xf
  v_dot2c_f32_bf16_dpp v139, v80, v79 row_newbcast:15 row_mask:0xf bank_mask:0xf
  s_waitcnt lgkmcnt(0)
  v_pk_add_f32 v[120:121], v[120:121], v[122:123]
  v_pk_add_f32 v[124:125], v[124:125], v[126:127]
  v_pk_add_f32 v[128:129], v[128:129], v[130:131]
  v_pk_add_f32 v[132:133], v[132:133], v[134:135]
  v_pk_add_f32 v[140:141], v[136:137], v[138:139]
  v_pk_add_f32 v[120:121], v[120:121], v[124:125]
  v_pk_add_f32 v[128:129], v[128:129], v[132:133]
  v_pk_add_f32 v[140:141], v[140:141], v[120:121]
  v_pk_add_f32 v[140:141], v[140:141], v[128:129]
  buffer_store_dwordx4 v[140:143], v12, s[16:19], s23 offen sc1
  s_cmp_ge_u32 s78, 80
  s_cbranch_scc1 L_hfin
  s_sleep 10
  s_mov_b32 s33, 0x80000
L_g_41:
  buffer_load_dwordx4 v[16:19], v147, s[16:19], s68 offen offset:1024 sc1
  buffer_load_dwordx4 v[20:23], v147, s[16:19], s69 offen offset:1024 sc1
  buffer_load_dwordx4 v[24:27], v147, s[16:19], s70 offen offset:1024 sc1
  buffer_load_dwordx4 v[28:31], v147, s[16:19], s68 offen offset:0 sc1
  buffer_load_dwordx4 v[32:35], v147, s[16:19], s69 offen offset:0 sc1
  buffer_load_dwordx4 v[36:39], v147, s[16:19], s70 offen offset:0 sc1
  s_waitcnt vmcnt(5)
  v_xor_b32 v3, s6, v19
  s_waitcnt vmcnt(4)
  v_bitop3_b32 v3, v3, s6, v23 bitop3:0xf6
  s_waitcnt vmcnt(3)
  v_bitop3_b32 v3, v3, s6, v27 bitop3:0xf6
  s_waitcnt vmcnt(2)
  v_bitop3_b32 v3, v3, s6, v31 bitop3:0xf6
  s_waitcnt vmcnt(1)
  v_bitop3_b32 v3, v3, s6, v35 bitop3:0xf6
  s_waitcnt vmcnt(0)
  v_bitop3_b32 v3, v3, s6, v39 bitop3:0xf6
  v_cmp_ne_u32 vcc, 0, v3
  s_nop 0
  s_and_b64 exec, exec, vcc
  s_cbranch_scc0 L_gd_42
  s_sub_u32 s33, s33, 1
  s_cbranch_scc0 L_g_41
L_gd_42:
  s_mov_b64 exec, -1
  v_pk_add_f32 v[112:113], v[16:17], v[20:21]
  v_pk_add_f32 v[124:125], v[28:29], v[32:33]
  v_pk_add_f32 v[112:113], v[112:113], v[24:25]
  v_pk_add_f32 v[124:125], v[124:125], v[36:37]
  s_nop 0
  v_add_f32_dpp v112, v112, v112 row_ror:4 row_mask:0xf bank_mask:0xf
  v_add_f32_dpp v113, v113, v113 row_ror:4 row_mask:0xf bank_mask:0xf
  v_add_f32_dpp v124, v124, v124 row_ror:4 row_mask:0xf bank_mask:0xf
  v_add_f32_dpp v125, v125, v125 row_ror:4 row_mask:0xf bank_mask:0xf
  v_add_f32_dpp v112, v112, v112 row_ror:8 row_mask:0xf bank_mask:0xf
  v_add_f32_dpp v113, v113, v113 row_ror:8 row_mask:0xf bank_mask:0xf
  v_add_f32_dpp v124, v124, v124 row_ror:8 row_mask:0xf bank_mask:0xf
  v_add_f32_dpp v125, v125, v125 row_ror:8 row_mask:0xf bank_mask:0xf
  v_mov_b32 v116, v112
  v_mov_b32 v117, v113
  v_mov_b32 v118, v124
  v_mov_b32 v119, v125
  v_permlane16_swap_b32 v112, v116
  v_permlane16_swap_b32 v113, v117
  v_permlane16_swap_b32 v124, v118
  v_permlane16_swap_b32 v125, v119
  v_add_f32 v112, v112, v116
  v_add_f32 v113, v113, v117
  v_add_f32 v124, v124, v118
  v_add_f32 v125, v125, v119
  v_mov_b32 v116, v112
  v_mov_b32 v117, v113
  v_mov_b32 v118, v124
  v_mov_b32 v119, v125
  v_permlane32_swap_b32 v112, v116
  v_permlane32_swap_b32 v113, v117
  v_permlane32_swap_b32 v124, v118
  v_permlane32_swap_b32 v125, v119
  v_add_f32 v112, v112, v116
  v_add_f32 v113, v113, v117
  v_add_f32 v124, v124, v118
  v_add_f32 v125, v125, v119
  v_cvt_pk_bf16_f32 v124, v124, v125
  v_cvt_pk_bf16_f32 v112, v112, v113
  v_lshlrev_b32 v116, 16, v124
  v_and_b32 v117, 0xffff0000, v124
  v_pk_add_f32 v[116:117], v[116:117], v[152:153]
  v_lshlrev_b32 v118, 16, v112
  v_and_b32 v119, 0xffff0000, v112
  v_cvt_pk_bf16_f32 v114, v116, v117
  v_lshlrev_b32 v116, 16, v114
  v_and_b32 v117, 0xffff0000, v114
  v_pk_add_f32 v[116:117], v[116:117], v[118:119]
  v_cvt_pk_bf16_f32 v113, v116, v117
  s_mov_b64 exec, 15
  buffer_store_dword v113, v148, s[12:15], 0 offen
L_hfin:
  s_endpgm
L_far_1:
  buffer_store_dwordx4 v[16:19], v12, s[16:19], s30 offen sc1
  s_nop 1
  s_branch L_back_2
L_far_13:
  buffer_store_dwordx4 v[52:55], v49, s[16:19], s28 offen sc1
  s_nop 1
  s_branch L_back_14
L_far_17:
  buffer_store_dwordx4 v[52:55], v12, s[16:19], s31 offen sc1
  s_nop 1
  s_branch L_back_18
L_far_27:
  buffer_store_dwordx4 v[112:115], v145, s[16:19], s31 offen sc1
  buffer_store_dwordx4 v[116:119], v145, s[16:19], s31 offen offset:16 sc1
  s_nop 1
  s_branch L_back_28
L_far_31:
  buffer_store_dwordx4 v[112:115], v161, s[16:19], s71 offen sc1
  s_nop 1
  s_branch L_back_32
L_far_37:
  buffer_store_dwordx4 v[112:115], v145, s[16:19], s31 offen sc1
  buffer_store_dwordx4 v[116:119], v145, s[16:19], s31 offen offset:16 sc1
  s_nop 1
  s_branch L_back_38
.p2align 10
L_stream:
  s_sub_u32 s6, s3, 1
  v_mul_u32_u24 v2, 384, v9
  v_lshl_add_u32 v2, v10, 4, v2
  s_mul_i32 s29, s4, 12582912
  s_lshl2_add_u32 s78, s5, s6
  s_mul_i32 s78, s78, 3072
  s_add_u32 s29, s29, s78
  s_add_u32 s28, s29, 301989888
  s_mov_b32 s77, 393216
  v_lshlrev_b32 v3, 2, v1
  s_lshl_b32 s7, s6, 8
  s_add_u32 s7, s7, 113152
  v_add_u32 v114, s7, v3
  ds_write_b32 v3, v13 offset:0
  ds_write_b32 v114, v13
  s_setprio 1
  v_and_b32 v3, 1, v10
  v_lshlrev_b32 v3, 4, v3
  v_mov_b32 v8, 0xffff
  v_lshlrev_b32 v8, v3, v8
  v_lshrrev_b32 v3, 1, v10
  v_cmp_eq_u32 vcc, 0, v3
  s_nop 1
  v_cndmask_b32 v4, 0, v8, vcc
  v_cmp_eq_u32 vcc, 1, v3
  s_nop 1
  v_cndmask_b32 v5, 0, v8, vcc
  v_cmp_eq_u32 vcc, 2, v3
  s_nop 1
  v_cndmask_b32 v6, 0, v8, vcc
  v_cmp_eq_u32 vcc, 3, v3
  s_nop 1
  v_cndmask_b32 v7, 0, v8, vcc
  v_lshrrev_b32 v3, 5, v1
  v_mul_u32_u24 v11, 768, v3
  v_lshl_add_u32 v11, v10, 5, v11
  v_and_b32 v3, 16, v1
  v_add_u32 v11, v11, v3
  s_mov_b32 s34, 0x00ff00ff
  s_mov_b32 s35, 0xff00ff00
  v_mul_u32_u24 v15, 3072, v9
  v_lshl_add_u32 v15, v10, 4, v15
  s_lshl_b32 s7, s6, 12
  v_lshl_add_u32 v109, v9, 9, s7
  v_add_u32 v109, 7680, v109
  v_lshl_add_u32 v108, v10, 2, v109
  v_lshlrev_b32 v110, 4, v10
  s_mul_i32 s7, s6, 1536
  v_add_u32 v121, s7, v11
  v_add_u32 v111, 30208, v121
  v_mov_b32 v112, 0
  v_mov_b32 v113, 1
  v_mov_b32 v115, 0
  s_lshl_b32 s7, s6, 3
  v_mov_b32 v118, s7
  v_mov_b32 v116, 0
  v_mov_b32 v117, 0
  s_mov_b32 s79, s77
  s_and_b32 s7, s4, 3
  s_add_u32 s7, s7, 28
  s_mul_i32 s7, s7, 393216
  s_add_u32 s78, s78, s7
  s_lshr_b32 s7, s4, 2
  s_sub_u32 s7, 23, s7
  s_mul_i32 s7, s7, 12582912
  s_add_u32 s78, s78, s7
  s_mov_b32 s60, 0x01010101
  s_mov_b32 s61, s60
  s_lshl_b64 s[62:63], s[60:61], 1
  s_lshl_b64 s[64:65], s[60:61], 2
  s_lshl_b64 s[66:67], s[60:61], 3
  s_lshl_b64 s[68:69], s[60:61], 4
  s_lshl_b64 s[70:71], s[60:61], 5
  s_lshl_b64 s[72:73], s[60:61], 6
  s_lshl_b64 s[74:75], s[60:61], 7
  s_waitcnt lgkmcnt(0)
  s_mov_b64 s[8:9], s[38:39]
  s_mov_b32 s10, 402653184
  s_mov_b32 s11, 0x20000
  s_mov_b64 s[12:13], s[44:45]
  s_mov_b32 s14, 7864320
  s_mov_b32 s15, 0x20000
  s_mov_b64 s[16:17], s[52:53]
  s_mov_b32 s18, 1966080
  s_mov_b32 s19, 0x20000
  s_cmp_lt_u32 s5, 16
  s_cselect_b64 s[20:21], s[48:49], s[50:51]
  s_mov_b32 s22, 1966080
  s_mov_b32 s23, 0x20000
  s_mul_hi_u32 s25, s5, 0x33333334
  s_mul_i32 s7, s25, 5
  s_sub_u32 s7, s5, s7
  s_lshl_b32 s7, s7, 8
  s_mul_i32 s25, s25, 40960
  s_add_u32 s25, s25, s7
  s_lshr_b32 s7, s6, 1
  s_lshl_b32 s7, s7, 4
  s_sub_u32 s24, 16, s7
  s_add_u32 s24, s24, s4
  s_mul_i32 s24, s24, 245760
  s_add_u32 s24, s24, s25
  s_and_b32 s7, s6, 1
  s_mul_i32 s7, s7, 20480
  s_add_u32 s24, s24, s7
  s_add_u32 s76, s24, 1966080
  v_mul_u32_u24 v119, 1280, v9
  v_lshl_add_u32 v119, v10, 4, v119
  s_lshl_b32 s7, s6, 6
  s_add_u32 s7, s7, 3328
  v_lshl_add_u32 v120, v9, 2, s7
  s_mul_i32 s26, s4, 245760
  s_add_u32 s26, s26, s25
  s_mul_i32 s7, s6, 10240
  s_add_u32 s26, s26, s7
  v_lshrrev_b32 v3, 4, v1
  v_and_b32 v8, 15, v1
  v_mul_u32_u24 v3, 1280, v3
  v_lshl_add_u32 v8, v8, 4, v3
  s_and_b32 s27, s5, 15
  s_mul_i32 s27, s27, 122880
  s_mul_i32 s25, s4, 384
  s_add_u32 s27, s27, s25
  s_barrier
  s_mul_i32 s25, s6, 24576
  s_add_u32 s25, s25, s27
  s_mul_i32 s31, s6, 3072
  s_add_u32 m0, s31, 97792
  s_waitcnt vmcnt(5)
  buffer_load_dwordx4 v15, s[20:23], s25 offen nt lds
  s_add_u32 s25, s25, 128
  s_add_u32 m0, m0, 1024
  s_waitcnt vmcnt(5)
  buffer_load_dwordx4 v15, s[20:23], s25 offen nt lds
  s_add_u32 s25, s25, 128
  s_add_u32 m0, m0, 1024
  s_waitcnt vmcnt(5)
  buffer_load_dwordx4 v15, s[20:23], s25 offen nt lds
  s_cmp_eq_u32 s6, 3
  s_cbranch_scc1 L_nogu
  s_lshl_b32 s25, s6, 7
  s_add_u32 s25, s25, s27
  s_add_u32 s25, s25, 98304
  s_lshl_b32 s31, s6, 10
  s_add_u32 m0, s31, 110080
  s_waitcnt vmcnt(5)
  buffer_load_dwordx4 v15, s[20:23], s25 offen nt lds
L_nogu:
  s_cmp_ge_u32 s5, 30
  s_cselect_b32 s14, 0, s14
  s_cbranch_scc1 L_now
  s_lshl_b32 s31, s6, 11
  s_add_u32 m0, s31, 73216
  s_waitcnt vmcnt(5)
  buffer_load_dwordx4 v8, s[16:19], s26 offen nt lds
  s_add_u32 s26, s26, 5120
  s_add_u32 m0, m0, 1024
  s_waitcnt vmcnt(5)
  buffer_load_dwordx4 v8, s[16:19], s26 offen nt lds
  s_lshl_b32 s31, s6, 12
  s_add_u32 m0, s31, 81408
  s_waitcnt vmcnt(5)
  buffer_load_dwordx4 v8, s[12:15], s24 offen nt lds
  s_add_u32 s24, s24, 5120
  s_add_u32 m0, m0, 1024
  s_waitcnt vmcnt(5)
  buffer_load_dwordx4 v8, s[12:15], s24 offen nt lds
  s_add_u32 s24, s24, 5120
  s_add_u32 m0, m0, 1024
  s_waitcnt vmcnt(5)
  buffer_load_dwordx4 v8, s[12:15], s24 offen nt lds
  s_add_u32 s24, s24, 5120
  s_add_u32 m0, m0, 1024
  s_waitcnt vmcnt(5)
  buffer_load_dwordx4 v8, s[12:15], s24 offen nt lds
L_now:
  s_waitcnt vmcnt(5)
  buffer_load_dwordx4 v[16:19], v2, s[8:11], s28 offen offset:0 nt
  s_waitcnt vmcnt(5)
  buffer_load_dwordx4 v[20:23], v2, s[8:11], s28 offen offset:128 nt
  s_waitcnt vmcnt(5)
  buffer_load_dwordx4 v[24:27], v2, s[8:11], s28 offen offset:256 nt
  s_add_u32 s28, s28, s77
  s_waitcnt vmcnt(5)
  buffer_load_dwordx4 v[28:31], v2, s[8:11], s28 offen offset:0 nt
  s_waitcnt vmcnt(5)
  buffer_load_dwordx4 v[32:35], v2, s[8:11], s28 offen offset:128 nt
  s_waitcnt vmcnt(5)
  buffer_load_dwordx4 v[36:39], v2, s[8:11], s28 offen offset:256 nt
  s_add_u32 s28, s28, s77
  s_waitcnt vmcnt(5)
  buffer_load_dwordx4 v[40:43], v2, s[8:11], s28 offen offset:0 nt
  s_waitcnt vmcnt(5)
  buffer_load_dwordx4 v[44:47], v2, s[8:11], s28 offen offset:128 nt
  s_waitcnt vmcnt(5)
  buffer_load_dwordx4 v[48:51], v2, s[8:11], s28 offen offset:256 nt
  s_add_u32 s28, s28, s77
  s_waitcnt vmcnt(5)
  buffer_load_dwordx4 v[52:55], v2, s[8:11], s28 offen offset:0 nt
  s_mov_b32 s30, 0
L_k:
  s_min_u32 s31, s30, 1
  s_add_u32 s31, s31, 1
  s_mov_b32 s33, 0x800000
L_w_43:
  ds_read_b32 v3, v13 offset:0
  ds_read_b128 v[64:67], v110 offset:256
  ds_read_b128 v[68:71], v110 offset:384
  ds_read_b128 v[72:75], v110 offset:512
  s_waitcnt lgkmcnt(0)
  v_readfirstlane_b32 s32, v3
  s_nop 0
  s_cmp_ge_u32 s32, s31
  s_cbranch_scc1 L_d_44
  s_sleep 1
  s_sub_u32 s33, s33, 1
  s_cbranch_scc0 L_w_43
L_d_44:
  v_add_u32 v110, 384, v110
L_k_body:
  s_waitcnt lgkmcnt(1)
  v_cmp_gt_u32 vcc, v116, v115
  v_cmp_gt_u32 s[0:1], v117, v115
  ds_read_b64 v[116:117], v118 offset:64
  s_cmp_lg_u64 s[0:1], 0
  s_cbranch_scc0 L_q_46
  s_waitcnt vmcnt(3)
L_q_46:
  s_waitcnt vmcnt(5)
  s_cbranch_vccnz L_p_45
  s_waitcnt vmcnt(4)
L_p_45:
  buffer_load_dwordx4 v[56:59], v2, s[8:11], s28 offen offset:128 nt
  v_mov_b32 v76, 0
  v_dot2c_f32_bf16 v76, v16, v64
  v_dot2c_f32_bf16 v76, v17, v65
  v_dot2c_f32_bf16 v76, v18, v66
  v_dot2c_f32_bf16 v76, v19, v67
  v_add_u32 v115, 1, v115
  ds_write_b32 v114, v115
  s_cmp_lg_u64 s[0:1], 0
  s_cbranch_scc0 L_q_48
  s_waitcnt vmcnt(3)
L_q_48:
  s_waitcnt vmcnt(5)
  s_cbranch_vccnz L_p_47
  s_waitcnt vmcnt(4)
L_p_47:
  buffer_load_dwordx4 v[60:63], v2, s[8:11], s28 offen offset:256 nt
  s_add_u32 s28, s28, s77
  v_dot2c_f32_bf16 v76, v20, v68
  v_dot2c_f32_bf16 v76, v21, v69
  v_dot2c_f32_bf16 v76, v22, v70
  v_dot2c_f32_bf16 v76, v23, v71
  v_add_u32 v115, 1, v115
  ds_write_b32 v114, v115
  s_cmp_lg_u64 s[0:1], 0
  s_cbranch_scc0 L_q_50
  s_waitcnt vmcnt(3)
L_q_50:
  s_waitcnt vmcnt(5)
  s_cbranch_vccnz L_p_49
  s_waitcnt vmcnt(4)
L_p_49:
  buffer_load_dwordx4 v[16:19], v2, s[8:11], s28 offen offset:0 nt
  v_dot2c_f32_bf16 v76, v24, v72
  v_dot2c_f32_bf16 v76, v25, v73
  v_dot2c_f32_bf16 v76, v26, v74
  v_dot2c_f32_bf16 v76, v27, v75
  v_add_u32 v115, 1, v115
  ds_write_b32 v114, v115
  s_nop 0
  v_add_f32_dpp v76, v76, v76 quad_perm:[1,0,3,2] row_mask:0xf bank_mask:0xf
  s_nop 1
  v_add_f32_dpp v76, v76, v76 quad_perm:[2,3,0,1] row_mask:0xf bank_mask:0xf
  s_nop 1
  v_add_f32_dpp v76, v76, v76 row_half_mirror row_mask:0xf bank_mask:0xf
  v_cndmask_b32 v77, v77, v76, s[60:61]
  s_waitcnt lgkmcnt(1)
  v_cmp_gt_u32 vcc, v116, v115
  v_cmp_gt_u32 s[0:1], v117, v115
  ds_read_b64 v[116:117], v118 offset:64
  s_cmp_lg_u64 s[0:1], 0
  s_cbranch_scc0 L_q_52
  s_waitcnt vmcnt(3)
L_q_52:
  s_waitcnt vmcnt(5)
  s_cbranch_vccnz L_p_51
  s_waitcnt vmcnt(4)
L_p_51:
  buffer_load_dwordx4 v[20:23], v2, s[8:11], s28 offen offset:128 nt
  v_mov_b32 v76, 0
  v_dot2c_f32_bf16 v76, v28, v64
  v_dot2c_f32_bf16 v76, v29, v65
  v_dot2c_f32_bf16 v76, v30, v66
  v_dot2c_f32_bf16 v76, v31, v67
  v_add_u32 v115, 1, v115
  ds_write_b32 v114, v115
  s_cmp_lg_u64 s[0:1], 0
  s_cbranch_scc0 L_q_54
  s_waitcnt vmcnt(3)
L_q_54:
  s_waitcnt vmcnt(5)
  s_cbranch_vccnz L_p_53
  s_waitcnt vmcnt(4)
L_p_53:
  buffer_load_dwordx4 v[24:27], v2, s[8:11], s28 offen offset:256 nt
  s_add_u32 s28, s28, s77
  v_dot2c_f32_bf16 v76, v32, v68
  v_dot2c_f32_bf16 v76, v33, v69
  v_dot2c_f32_bf16 v76, v34, v70
  v_dot2c_f32_bf16 v76, v35, v71
  v_add_u32 v115, 1, v115
  ds_write_b32 v114, v115
  s_cmp_lg_u64 s[0:1], 0
  s_cbranch_scc0 L_q_56
  s_waitcnt vmcnt(3)
L_q_56:
  s_waitcnt vmcnt(5)
  s_cbranch_vccnz L_p_55
  s_waitcnt vmcnt(4)
L_p_55:
  buffer_load_dwordx4 v[28:31], v2, s[8:11], s28 offen offset:0 nt
  v_dot2c_f32_bf16 v76, v36, v72
  v_dot2c_f32_bf16 v76, v37, v73
  v_dot2c_f32_bf16 v76, v38, v74
  v_dot2c_f32_bf16 v76, v39, v75
  v_add_u32 v115, 1, v115
  ds_write_b32 v114, v115
  s_nop 0
  v_add_f32_dpp v76, v76, v76 quad_perm:[1,0,3,2] row_mask:0xf bank_mask:0xf
  s_nop 1
  v_add_f32_dpp v76, v76, v76 quad_perm:[2,3,0,1] row_mask:0xf bank_mask:0xf
  s_nop 1
  v_add_f32_dpp v76, v76, v76 row_half_mirror row_mask:0xf bank_mask:0xf
  v_cndmask_b32 v77, v77, v76, s[62:63]
  s_waitcnt lgkmcnt(1)
  v_cmp_gt_u32 vcc, v116, v115
  v_cmp_gt_u32 s[0:1], v117, v115
  ds_read_b64 v[116:117], v118 offset:64
  s_cmp_lg_u64 s[0:1], 0
  s_cbranch_scc0 L_q_58
  s_waitcnt vmcnt(3)
L_q_58:
  s_waitcnt vmcnt(5)
  s_cbranch_vccnz L_p_57
  s_waitcnt vmcnt(4)
L_p_57:
  buffer_load_dwordx4 v[32:35], v2, s[8:11], s28 offen offset:128 nt
  v_mov_b32 v76, 0
  v_dot2c_f32_bf16 v76, v40, v64
  v_dot2c_f32_bf16 v76, v41, v65
  v_dot2c_f32_bf16 v76, v42, v66
  v_dot2c_f32_bf16 v76, v43, v67
  v_add_u32 v115, 1, v115
  ds_write_b32 v114, v115
  s_cmp_lg_u64 s[0:1], 0
  s_cbranch_scc0 L_q_60
  s_waitcnt vmcnt(3)
L_q_60:
  s_waitcnt vmcnt(5)
  s_cbranch_vccnz L_p_59
  s_waitcnt vmcnt(4)
L_p_59:
  buffer_load_dwordx4 v[36:39], v2, s[8:11], s28 offen offset:256 nt
  s_add_u32 s28, s28, s77
  v_dot2c_f32_bf16 v76, v44, v68
  v_dot2c_f32_bf16 v76, v45, v69
  v_dot2c_f32_bf16 v76, v46, v70
  v_dot2c_f32_bf16 v76, v47, v71
  v_add_u32 v115, 1, v115
  ds_write_b32 v114, v115
  s_cmp_lg_u64 s[0:1], 0
  s_cbranch_scc0 L_q_62
  s_waitcnt vmcnt(3)
L_q_62:
  s_waitcnt vmcnt(5)
  s_cbranch_vccnz L_p_61
  s_waitcnt vmcnt(4)
L_p_61:
  buffer_load_dwordx4 v[40:43], v2, s[8:11], s28 offen offset:0 nt
  v_dot2c_f32_bf16 v76, v48, v72
  v_dot2c_f32_bf16 v76, v49, v73
  v_dot2c_f32_bf16 v76, v50, v74
  v_dot2c_f32_bf16 v76, v51, v75
  v_add_u32 v115, 1, v115
  ds_write_b32 v114, v115
  s_nop 0
  v_add_f32_dpp v76, v76, v76 quad_perm:[1,0,3,2] row_mask:0xf bank_mask:0xf
  s_nop 1
  v_add_f32_dpp v76, v76, v76 quad_perm:[2,3,0,1] row_mask:0xf bank_mask:0xf
  s_nop 1
  v_add_f32_dpp v76, v76, v76 row_half_mirror row_mask:0xf bank_mask:0xf
  v_cndmask_b32 v77, v77, v76, s[64:65]
  s_waitcnt lgkmcnt(1)
  v_cmp_gt_u32 vcc, v116, v115
  v_cmp_gt_u32 s[0:1], v117, v115
  ds_read_b64 v[116:117], v118 offset:64
  s_cmp_lg_u64 s[0:1], 0
  s_cbranch_scc0 L_q_64
  s_waitcnt vmcnt(3)
L_q_64:
  s_waitcnt vmcnt(5)
  s_cbranch_vccnz L_p_63
  s_waitcnt vmcnt(4)
L_p_63:
  buffer_load_dwordx4 v[44:47], v2, s[8:11], s28 offen offset:128 nt
  v_mov_b32 v76, 0
  v_dot2c_f32_bf16 v76, v52, v64
  v_dot2c_f32_bf16 v76, v53, v65
  v_dot2c_f32_bf16 v76, v54, v66
  v_dot2c_f32_bf16 v76, v55, v67
  v_add_u32 v115, 1, v115
  ds_write_b32 v114, v115
  s_cmp_lg_u64 s[0:1], 0
  s_cbranch_scc0 L_q_66
  s_waitcnt vmcnt(3)
L_q_66:
  s_waitcnt vmcnt(5)
  s_cbranch_vccnz L_p_65
  s_waitcnt vmcnt(4)
L_p_65:
  buffer_load_dwordx4 v[48:51], v2, s[8:11], s28 offen offset:256 nt
  s_add_u32 s28, s28, s77
  v_dot2c_f32_bf16 v76, v56, v68
  v_dot2c_f32_bf16 v76, v57, v69
  v_dot2c_f32_bf16 v76, v58, v70
  v_dot2c_f32_bf16 v76, v59, v71
  v_add_u32 v115, 1, v115
  ds_write_b32 v114, v115
  s_cmp_lg_u64 s[0:1], 0
  s_cbranch_scc0 L_q_68
  s_waitcnt vmcnt(3)
L_q_68:
  s_waitcnt vmcnt(5)
  s_cbranch_vccnz L_p_67
  s_waitcnt vmcnt(4)
L_p_67:
  buffer_load_dwordx4 v[52:55], v2, s[8:11], s28 offen offset:0 nt
  v_dot2c_f32_bf16 v76, v60, v72
  v_dot2c_f32_bf16 v76, v61, v73
  v_dot2c_f32_bf16 v76, v62, v74
  v_dot2c_f32_bf16 v76, v63, v75
  v_add_u32 v115, 1, v115
  ds_write_b32 v114, v115
  s_nop 0
  v_add_f32_dpp v76, v76, v76 quad_perm:[1,0,3,2] row_mask:0xf bank_mask:0xf
  s_nop 1
  v_add_f32_dpp v76, v76, v76 quad_perm:[2,3,0,1] row_mask:0xf bank_mask:0xf
  s_nop 1
  v_add_f32_dpp v76, v76, v76 row_half_mirror row_mask:0xf bank_mask:0xf
  v_cndmask_b32 v77, v77, v76, s[66:67]
  s_waitcnt lgkmcnt(1)
  v_cmp_gt_u32 vcc, v116, v115
  v_cmp_gt_u32 s[0:1], v117, v115
  ds_read_b64 v[116:117], v118 offset:64
  s_cmp_lg_u64 s[0:1], 0
  s_cbranch_scc0 L_q_70
  s_waitcnt vmcnt(3)
L_q_70:
  s_waitcnt vmcnt(5)
  s_cbranch_vccnz L_p_69
  s_waitcnt vmcnt(4)
L_p_69:
  buffer_load_dwordx4 v[56:59], v2, s[8:11], s28 offen offset:128 nt
  v_mov_b32 v76, 0
  v_dot2c_f32_bf16 v76, v16, v64
  v_dot2c_f32_bf16 v76, v17, v65
  v_dot2c_f32_bf16 v76, v18, v66
  v_dot2c_f32_bf16 v76, v19, v67
  v_add_u32 v115, 1, v115
  ds_write_b32 v114, v115
  s_cmp_lg_u64 s[0:1], 0
  s_cbranch_scc0 L_q_72
  s_waitcnt vmcnt(3)
L_q_72:
  s_waitcnt vmcnt(5)
  s_cbranch_vccnz L_p_71
  s_waitcnt vmcnt(4)
L_p_71:
  buffer_load_dwordx4 v[60:63], v2, s[8:11], s28 offen offset:256 nt
  s_add_u32 s28, s28, s79
  s_cmp_eq_u32 s30, 3
  s_cselect_b32 s28, s78, s28
  s_cselect_b32 s79, 4280811520, s79
  s_cselect_b32 s77, 4293394432, s77
  s_add_u32 s31, s29, 100663296
  s_cmp_eq_u32 s30, 7
  s_cselect_b32 s28, s31, s28
  s_cselect_b32 s77, 393216, s77
  s_cselect_b32 s79, s77, s79
  s_cmp_eq_u32 s30, 11
  s_cselect_b32 s28, s29, s28
  s_add_u32 s31, s29, 301989888
  s_cmp_eq_u32 s30, 15
  s_cselect_b32 s28, s31, s28
  s_cselect_b64 s[8:9], s[40:41], s[8:9]
  v_dot2c_f32_bf16 v76, v20, v68
  v_dot2c_f32_bf16 v76, v21, v69
  v_dot2c_f32_bf16 v76, v22, v70
  v_dot2c_f32_bf16 v76, v23, v71
  v_add_u32 v115, 1, v115
  ds_write_b32 v114, v115
  s_cmp_lg_u64 s[0:1], 0
  s_cbranch_scc0 L_q_74
  s_waitcnt vmcnt(3)
L_q_74:
  s_waitcnt vmcnt(5)
  s_cbranch_vccnz L_p_73
  s_waitcnt vmcnt(4)
L_p_73:
  buffer_load_dwordx4 v[16:19], v2, s[8:11], s28 offen offset:0 nt
  v_dot2c_f32_bf16 v76, v24, v72
  v_dot2c_f32_bf16 v76, v25, v73
  v_dot2c_f32_bf16 v76, v26, v74
  v_dot2c_f32_bf16 v76, v27, v75
  v_add_u32 v115, 1, v115
  ds_write_b32 v114, v115
  s_nop 0
  v_add_f32_dpp v76, v76, v76 quad_perm:[1,0,3,2] row_mask:0xf bank_mask:0xf
  s_nop 1
  v_add_f32_dpp v76, v76, v76 quad_perm:[2,3,0,1] row_mask:0xf bank_mask:0xf
  s_nop 1
  v_add_f32_dpp v76, v76, v76 row_half_mirror row_mask:0xf bank_mask:0xf
  v_cndmask_b32 v77, v77, v76, s[68:69]
  s_waitcnt lgkmcnt(1)
  v_cmp_gt_u32 vcc, v116, v115
  v_cmp_gt_u32 s[0:1], v117, v115
  ds_read_b64 v[116:117], v118 offset:64
  s_cmp_lg_u64 s[0:1], 0
  s_cbranch_scc0 L_q_76
  s_waitcnt vmcnt(3)
L_q_76:
  s_waitcnt vmcnt(5)
  s_cbranch_vccnz L_p_75
  s_waitcnt vmcnt(4)
L_p_75:
  buffer_load_dwordx4 v[20:23], v2, s[8:11], s28 offen offset:128 nt
  v_mov_b32 v76, 0
  v_dot2c_f32_bf16 v76, v28, v64
  v_dot2c_f32_bf16 v76, v29, v65
  v_dot2c_f32_bf16 v76, v30, v66
  v_dot2c_f32_bf16 v76, v31, v67
  v_add_u32 v115, 1, v115
  ds_write_b32 v114, v115
  s_cmp_lg_u64 s[0:1], 0
  s_cbranch_scc0 L_q_78
  s_waitcnt vmcnt(3)
L_q_78:
  s_waitcnt vmcnt(5)
  s_cbranch_vccnz L_p_77
  s_waitcnt vmcnt(4)
L_p_77:
  buffer_load_dwordx4 v[24:27], v2, s[8:11], s28 offen offset:256 nt
  s_add_u32 s28, s28, s77
  v_dot2c_f32_bf16 v76, v32, v68
  v_dot2c_f32_bf16 v76, v33, v69
  v_dot2c_f32_bf16 v76, v34, v70
  v_dot2c_f32_bf16 v76, v35, v71
  v_add_u32 v115, 1, v115
  ds_write_b32 v114, v115
  s_cmp_lg_u64 s[0:1], 0
  s_cbranch_scc0 L_q_80
  s_waitcnt vmcnt(3)
L_q_80:
  s_waitcnt vmcnt(5)
  s_cbranch_vccnz L_p_79
  s_waitcnt vmcnt(4)
L_p_79:
  buffer_load_dwordx4 v[28:31], v2, s[8:11], s28 offen offset:0 nt
  v_dot2c_f32_bf16 v76, v36, v72
  v_dot2c_f32_bf16 v76, v37, v73
  v_dot2c_f32_bf16 v76, v38, v74
  v_dot2c_f32_bf16 v76, v39, v75
  v_add_u32 v115, 1, v115
  ds_write_b32 v114, v115
  s_nop 0
  v_add_f32_dpp v76, v76, v76 quad_perm:[1,0,3,2] row_mask:0xf bank_mask:0xf
  s_nop 1
  v_add_f32_dpp v76, v76, v76 quad_perm:[2,3,0,1] row_mask:0xf bank_mask:0xf
  s_nop 1
  v_add_f32_dpp v76, v76, v76 row_half_mirror row_mask:0xf bank_mask:0xf
  v_cndmask_b32 v77, v77, v76, s[70:71]
  s_waitcnt lgkmcnt(1)
  v_cmp_gt_u32 vcc, v116, v115
  v_cmp_gt_u32 s[0:1], v117, v115
  ds_read_b64 v[116:117], v118 offset:64
  s_cmp_lg_u64 s[0:1], 0
  s_cbranch_scc0 L_q_82
  s_waitcnt vmcnt(3)
L_q_82:
  s_waitcnt vmcnt(5)
  s_cbranch_vccnz L_p_81
  s_waitcnt vmcnt(4)
L_p_81:
  buffer_load_dwordx4 v[32:35], v2, s[8:11], s28 offen offset:128 nt
  v_mov_b32 v76, 0
  v_dot2c_f32_bf16 v76, v40, v64
  v_dot2c_f32_bf16 v76, v41, v65
  v_dot2c_f32_bf16 v76, v42, v66
  v_dot2c_f32_bf16 v76, v43, v67
  v_add_u32 v115, 1, v115
  ds_write_b32 v114, v115
  s_cmp_lg_u64 s[0:1], 0
  s_cbranch_scc0 L_q_84
  s_waitcnt vmcnt(3)
L_q_84:
  s_waitcnt vmcnt(5)
  s_cbranch_vccnz L_p_83
  s_waitcnt vmcnt(4)
L_p_83:
  buffer_load_dwordx4 v[36:39], v2, s[8:11], s28 offen offset:256 nt
  s_add_u32 s28, s28, s77
  v_dot2c_f32_bf16 v76, v44, v68
  v_dot2c_f32_bf16 v76, v45, v69
  v_dot2c_f32_bf16 v76, v46, v70
  v_dot2c_f32_bf16 v76, v47, v71
  v_add_u32 v115, 1, v115
  ds_write_b32 v114, v115
  s_cmp_lg_u64 s[0:1], 0
  s_cbranch_scc0 L_q_86
  s_waitcnt vmcnt(3)
L_q_86:
  s_waitcnt vmcnt(5)
  s_cbranch_vccnz L_p_85
  s_waitcnt vmcnt(4)
L_p_85:
  buffer_load_dwordx4 v[40:43], v2, s[8:11], s28 offen offset:0 nt
  v_dot2c_f32_bf16 v76, v48, v72
  v_dot2c_f32_bf16 v76, v49, v73
  v_dot2c_f32_bf16 v76, v50, v74
  v_dot2c_f32_bf16 v76, v51, v75
  v_add_u32 v115, 1, v115
  ds_write_b32 v114, v115
  s_nop 0
  v_add_f32_dpp v76, v76, v76 quad_perm:[1,0,3,2] row_mask:0xf bank_mask:0xf
  s_nop 1
  v_add_f32_dpp v76, v76, v76 quad_perm:[2,3,0,1] row_mask:0xf bank_mask:0xf
  s_nop 1
  v_add_f32_dpp v76, v76, v76 row_half_mirror row_mask:0xf bank_mask:0xf
  v_cndmask_b32 v77, v77, v76, s[72:73]
  s_waitcnt lgkmcnt(1)
  v_cmp_gt_u32 vcc, v116, v115
  v_cmp_gt_u32 s[0:1], v117, v115
  ds_read_b64 v[116:117], v118 offset:64
  s_cmp_lg_u64 s[0:1], 0
  s_cbranch_scc0 L_q_88
  s_waitcnt vmcnt(3)
L_q_88:
  s_waitcnt vmcnt(5)
  s_cbranch_vccnz L_p_87
  s_waitcnt vmcnt(4)
L_p_87:
  buffer_load_dwordx4 v[44:47], v2, s[8:11], s28 offen offset:128 nt
  v_mov_b32 v76, 0
  v_dot2c_f32_bf16 v76, v52, v64
  v_dot2c_f32_bf16 v76, v53, v65
  v_dot2c_f32_bf16 v76, v54, v66
  v_dot2c_f32_bf16 v76, v55, v67
  v_add_u32 v115, 1, v115
  ds_write_b32 v114, v115
  s_cmp_lg_u64 s[0:1], 0
  s_cbranch_scc0 L_q_90
  s_waitcnt vmcnt(3)
L_q_90:
  s_waitcnt vmcnt(5)
  s_cbranch_vccnz L_p_89
  s_waitcnt vmcnt(4)
L_p_89:
  buffer_load_dwordx4 v[48:51], v2, s[8:11], s28 offen offset:256 nt
  s_add_u32 s28, s28, s77
  v_dot2c_f32_bf16 v76, v56, v68
  v_dot2c_f32_bf16 v76, v57, v69
  v_dot2c_f32_bf16 v76, v58, v70
  v_dot2c_f32_bf16 v76, v59, v71
  v_add_u32 v115, 1, v115
  ds_write_b32 v114, v115
  s_cmp_lg_u64 s[0:1], 0
  s_cbranch_scc0 L_q_92
  s_waitcnt vmcnt(3)
L_q_92:
  s_waitcnt vmcnt(5)
  s_cbranch_vccnz L_p_91
  s_waitcnt vmcnt(4)
L_p_91:
  buffer_load_dwordx4 v[52:55], v2, s[8:11], s28 offen offset:0 nt
  v_dot2c_f32_bf16 v76, v60, v72
  v_dot2c_f32_bf16 v76, v61, v73
  v_dot2c_f32_bf16 v76, v62, v74
  v_dot2c_f32_bf16 v76, v63, v75
  v_add_u32 v115, 1, v115
  ds_write_b32 v114, v115
  s_nop 0
  v_add_f32_dpp v76, v76, v76 quad_perm:[1,0,3,2] row_mask:0xf bank_mask:0xf
  s_nop 1
  v_add_f32_dpp v76, v76, v76 quad_perm:[2,3,0,1] row_mask:0xf bank_mask:0xf
  s_nop 1
  v_add_f32_dpp v76, v76, v76 row_half_mirror row_mask:0xf bank_mask:0xf
  v_cndmask_b32 v77, v77, v76, s[74:75]
  ds_write_b32 v108, v77
  v_add_u32 v108, 32, v108
  s_add_u32 s30, s30, 1
  s_bitcmp1_b32 0x111f0, s30
  s_cbranch_scc0 L_k_body
  s_and_b32 s31, s30, 3
  s_cbranch_scc1 L_k
  s_mov_b64 exec, 1
  ds_add_u32 v112, v113 offset:16
  s_mov_b64 exec, -1
  v_add_u32 v112, 4, v112
  s_cmp_lt_u32 s30, 16
  s_cbranch_scc1 L_k
  s_mov_b32 s30, 0
  v_mov_b32 v112, 0
  s_mov_b32 s33, 0x800000
L_w_93:
  ds_read_b32 v3, v13 offset:4
  ds_read_b128 v[88:91], v109
  s_waitcnt lgkmcnt(0)
  v_readfirstlane_b32 s32, v3
  s_nop 0
  s_cmp_ge_u32 s32, 1
  s_cbranch_scc1 L_d_94
  s_sleep 1
  s_sub_u32 s33, s33, 1
  s_cbranch_scc0 L_w_93
L_d_94:
L_v:
  s_lshr_b32 s31, s30, 2
  s_add_u32 s31, s31, 2
  s_min_u32 s31, s31, 4
  s_mov_b32 s33, 0x800000
L_w_95:
  ds_read_b32 v3, v13 offset:4
  s_waitcnt lgkmcnt(0)
  v_readfirstlane_b32 s32, v3
  s_nop 0
  s_cmp_ge_u32 s32, s31
  s_cbranch_scc1 L_d_96
  s_sleep 1
  s_sub_u32 s33, s33, 1
  s_cbranch_scc0 L_w_95
L_d_96:
  v_mov_b32 v96, 0
  v_mov_b32 v97, 0
  v_mov_b32 v98, 0
  v_mov_b32 v99, 0
  v_mov_b32 v100, 0
  v_mov_b32 v101, 0
  v_mov_b32 v102, 0
  v_mov_b32 v103, 0
  v_mov_b32 v104, 0
  v_mov_b32 v105, 0
  v_mov_b32 v106, 0
  v_mov_b32 v107, 0
L_v_body:
  s_waitcnt lgkmcnt(1)
  v_cmp_gt_u32 vcc, v116, v115
  v_cmp_gt_u32 s[0:1], v117, v115
  ds_read_b64 v[116:117], v118 offset:64
  s_cmp_lg_u64 s[0:1], 0
  s_cbranch_scc0 L_q_98
  s_waitcnt vmcnt(3)
L_q_98:
  s_waitcnt vmcnt(5)
  s_cbranch_vccnz L_p_97
  s_waitcnt vmcnt(4)
L_p_97:
  buffer_load_dwordx4 v[56:59], v2, s[8:11], s28 offen offset:128 nt
  v_and_b32 v84, v88, v4
  v_and_b32 v85, v88, v5
  v_and_b32 v86, v88, v6
  v_and_b32 v87, v88, v7
  ds_read_b128 v[92:95], v109 offset:16
  s_nop 0
  v_mfma_f32_16x16x32_bf16 v[96:99], v[84:87], v[16:19], v[96:99]
  v_add_u32 v115, 1, v115
  ds_write_b32 v114, v115
  s_cmp_lg_u64 s[0:1], 0
  s_cbranch_scc0 L_q_100
  s_waitcnt vmcnt(3)
L_q_100:
  s_waitcnt vmcnt(5)
  s_cbranch_vccnz L_p_99
  s_waitcnt vmcnt(4)
L_p_99:
  buffer_load_dwordx4 v[60:63], v2, s[8:11], s28 offen offset:256 nt
  s_add_u32 s28, s28, s77
  v_mfma_f32_16x16x32_bf16 v[100:103], v[84:87], v[20:23], v[100:103]
  v_add_u32 v115, 1, v115
  ds_write_b32 v114, v115
  s_cmp_lg_u64 s[0:1], 0
  s_cbranch_scc0 L_q_102
  s_waitcnt vmcnt(3)
L_q_102:
  s_waitcnt vmcnt(5)
  s_cbranch_vccnz L_p_101
  s_waitcnt vmcnt(4)
L_p_101:
  buffer_load_dwordx4 v[16:19], v2, s[8:11], s28 offen offset:0 nt
  v_mfma_f32_16x16x32_bf16 v[104:107], v[84:87], v[24:27], v[104:107]
  v_add_u32 v115, 1, v115
  ds_write_b32 v114, v115
  s_waitcnt lgkmcnt(1)
  v_cmp_gt_u32 vcc, v116, v115
  v_cmp_gt_u32 s[0:1], v117, v115
  ds_read_b64 v[116:117], v118 offset:64
  s_cmp_lg_u64 s[0:1], 0
  s_cbranch_scc0 L_q_104
  s_waitcnt vmcnt(3)
L_q_104:
  s_waitcnt vmcnt(5)
  s_cbranch_vccnz L_p_103
  s_waitcnt vmcnt(4)
L_p_103:
  buffer_load_dwordx4 v[20:23], v2, s[8:11], s28 offen offset:128 nt
  v_and_b32 v84, v89, v4
  v_and_b32 v85, v89, v5
  v_and_b32 v86, v89, v6
  v_and_b32 v87, v89, v7
  s_nop 1
  v_mfma_f32_16x16x32_bf16 v[96:99], v[84:87], v[28:31], v[96:99]
  v_add_u32 v115, 1, v115
  ds_write_b32 v114, v115
  s_cmp_lg_u64 s[0:1], 0
  s_cbranch_scc0 L_q_106
  s_waitcnt vmcnt(3)
L_q_106:
  s_waitcnt vmcnt(5)
  s_cbranch_vccnz L_p_105
  s_waitcnt vmcnt(4)
L_p_105:
  buffer_load_dwordx4 v[24:27], v2, s[8:11], s28 offen offset:256 nt
  s_add_u32 s28, s28, s77
  v_mfma_f32_16x16x32_bf16 v[100:103], v[84:87], v[32:35], v[100:103]
  v_add_u32 v115, 1, v115
  ds_write_b32 v114, v115
  s_cmp_lg_u64 s[0:1], 0
  s_cbranch_scc0 L_q_108
  s_waitcnt vmcnt(3)
L_q_108:
  s_waitcnt vmcnt(5)
  s_cbranch_vccnz L_p_107
  s_waitcnt vmcnt(4)
L_p_107:
  buffer_load_dwordx4 v[28:31], v2, s[8:11], s28 offen offset:0 nt
  v_mfma_f32_16x16x32_bf16 v[104:107], v[84:87], v[36:39], v[104:107]
  v_add_u32 v115, 1, v115
  ds_write_b32 v114, v115
  s_waitcnt lgkmcnt(1)
  v_cmp_gt_u32 vcc, v116, v115
  v_cmp_gt_u32 s[0:1], v117, v115
  ds_read_b64 v[116:117], v118 offset:64
  s_cmp_lg_u64 s[0:1], 0
  s_cbranch_scc0 L_q_110
  s_waitcnt vmcnt(3)
L_q_110:
  s_waitcnt vmcnt(5)
  s_cbranch_vccnz L_p_109
  s_waitcnt vmcnt(4)
L_p_109:
  buffer_load_dwordx4 v[32:35], v2, s[8:11], s28 offen offset:128 nt
  v_and_b32 v84, v90, v4
  v_and_b32 v85, v90, v5
  v_and_b32 v86, v90, v6
  v_and_b32 v87, v90, v7
  s_nop 1
  v_mfma_f32_16x16x32_bf16 v[96:99], v[84:87], v[40:43], v[96:99]
  v_add_u32 v115, 1, v115
  ds_write_b32 v114, v115
  s_cmp_lg_u64 s[0:1], 0
  s_cbranch_scc0 L_q_112
  s_waitcnt vmcnt(3)
L_q_112:
  s_waitcnt vmcnt(5)
  s_cbranch_vccnz L_p_111
  s_waitcnt vmcnt(4)
L_p_111:
  buffer_load_dwordx4 v[36:39], v2, s[8:11], s28 offen offset:256 nt
  s_add_u32 s28, s28, s77
  v_mfma_f32_16x16x32_bf16 v[100:103], v[84:87], v[44:47], v[100:103]
  v_add_u32 v115, 1, v115
  ds_write_b32 v114, v115
  s_cmp_lg_u64 s[0:1], 0
  s_cbranch_scc0 L_q_114
  s_waitcnt vmcnt(3)
L_q_114:
  s_waitcnt vmcnt(5)
  s_cbranch_vccnz L_p_113
  s_waitcnt vmcnt(4)
L_p_113:
  buffer_load_dwordx4 v[40:43], v2, s[8:11], s28 offen offset:0 nt
  v_mfma_f32_16x16x32_bf16 v[104:107], v[84:87], v[48:51], v[104:107]
  v_add_u32 v115, 1, v115
  ds_write_b32 v114, v115
  s_waitcnt lgkmcnt(1)
  v_cmp_gt_u32 vcc, v116, v115
  v_cmp_gt_u32 s[0:1], v117, v115
  ds_read_b64 v[116:117], v118 offset:64
  s_cmp_lg_u64 s[0:1], 0
  s_cbranch_scc0 L_q_116
  s_waitcnt vmcnt(3)
L_q_116:
  s_waitcnt vmcnt(5)
  s_cbranch_vccnz L_p_115
  s_waitcnt vmcnt(4)
L_p_115:
  buffer_load_dwordx4 v[44:47], v2, s[8:11], s28 offen offset:128 nt
  v_and_b32 v84, v91, v4
  v_and_b32 v85, v91, v5
  v_and_b32 v86, v91, v6
  v_and_b32 v87, v91, v7
  s_nop 1
  v_mfma_f32_16x16x32_bf16 v[96:99], v[84:87], v[52:55], v[96:99]
  v_add_u32 v115, 1, v115
  ds_write_b32 v114, v115
  s_cmp_lg_u64 s[0:1], 0
  s_cbranch_scc0 L_q_118
  s_waitcnt vmcnt(3)
L_q_118:
  s_waitcnt vmcnt(5)
  s_cbranch_vccnz L_p_117
  s_waitcnt vmcnt(4)
L_p_117:
  buffer_load_dwordx4 v[48:51], v2, s[8:11], s28 offen offset:256 nt
  s_add_u32 s28, s28, s77
  v_mfma_f32_16x16x32_bf16 v[100:103], v[84:87], v[56:59], v[100:103]
  v_add_u32 v115, 1, v115
  ds_write_b32 v114, v115
  s_cmp_lg_u64 s[0:1], 0
  s_cbranch_scc0 L_q_120
  s_waitcnt vmcnt(3)
L_q_120:
  s_waitcnt vmcnt(5)
  s_cbranch_vccnz L_p_119
  s_waitcnt vmcnt(4)
L_p_119:
  buffer_load_dwordx4 v[52:55], v2, s[8:11], s28 offen offset:0 nt
  v_mfma_f32_16x16x32_bf16 v[104:107], v[84:87], v[60:63], v[104:107]
  v_add_u32 v115, 1, v115
  ds_write_b32 v114, v115
  s_waitcnt lgkmcnt(1)
  v_cmp_gt_u32 vcc, v116, v115
  v_cmp_gt_u32 s[0:1], v117, v115
  ds_read_b64 v[116:117], v118 offset:64
  s_cmp_lg_u64 s[0:1], 0
  s_cbranch_scc0 L_q_122
  s_waitcnt vmcnt(3)
L_q_122:
  s_waitcnt vmcnt(5)
  s_cbranch_vccnz L_p_121
  s_waitcnt vmcnt(4)
L_p_121:
  buffer_load_dwordx4 v[56:59], v2, s[8:11], s28 offen offset:128 nt
  v_and_b32 v84, v92, v4
  v_and_b32 v85, v92, v5
  v_and_b32 v86, v92, v6
  v_and_b32 v87, v92, v7
  ds_read_b128 v[88:91], v109 offset:32
  s_nop 0
  v_mfma_f32_16x16x32_bf16 v[96:99], v[84:87], v[16:19], v[96:99]
  v_add_u32 v115, 1, v115
  ds_write_b32 v114, v115
  s_cmp_lg_u64 s[0:1], 0
  s_cbranch_scc0 L_q_124
  s_waitcnt vmcnt(3)
L_q_124:
  s_waitcnt vmcnt(5)
  s_cbranch_vccnz L_p_123
  s_waitcnt vmcnt(4)
L_p_123:
  buffer_load_dwordx4 v[60:63], v2, s[8:11], s28 offen offset:256 nt
  s_add_u32 s28, s28, s79
  s_cmp_eq_u32 s30, 3
  s_cselect_b32 s28, s78, s28
  s_cselect_b32 s79, 4280811520, s79
  s_cselect_b32 s77, 4293394432, s77
  s_add_u32 s31, s29, 100663296
  s_cmp_eq_u32 s30, 7
  s_cselect_b32 s28, s31, s28
  s_cselect_b32 s77, 393216, s77
  s_cselect_b32 s79, s77, s79
  s_cmp_eq_u32 s30, 11
  s_cselect_b32 s28, s29, s28
  v_mfma_f32_16x16x32_bf16 v[100:103], v[84:87], v[20:23], v[100:103]
  v_add_u32 v115, 1, v115
  ds_write_b32 v114, v115
  s_cmp_lg_u64 s[0:1], 0
  s_cbranch_scc0 L_q_126
  s_waitcnt vmcnt(3)
L_q_126:
  s_waitcnt vmcnt(5)
  s_cbranch_vccnz L_p_125
  s_waitcnt vmcnt(4)
L_p_125:
  buffer_load_dwordx4 v[16:19], v2, s[8:11], s28 offen offset:0 nt
  v_mfma_f32_16x16x32_bf16 v[104:107], v[84:87], v[24:27], v[104:107]
  v_add_u32 v115, 1, v115
  ds_write_b32 v114, v115
  s_waitcnt lgkmcnt(1)
  v_cmp_gt_u32 vcc, v116, v115
  v_cmp_gt_u32 s[0:1], v117, v115
  ds_read_b64 v[116:117], v118 offset:64
  s_cmp_lg_u64 s[0:1], 0
  s_cbranch_scc0 L_q_128
  s_waitcnt vmcnt(3)
L_q_128:
  s_waitcnt vmcnt(5)
  s_cbranch_vccnz L_p_127
  s_waitcnt vmcnt(4)
L_p_127:
  buffer_load_dwordx4 v[20:23], v2, s[8:11], s28 offen offset:128 nt
  v_and_b32 v84, v93, v4
  v_and_b32 v85, v93, v5
  v_and_b32 v86, v93, v6
  v_and_b32 v87, v93, v7
  s_nop 1
  v_mfma_f32_16x16x32_bf16 v[96:99], v[84:87], v[28:31], v[96:99]
  v_add_u32 v115, 1, v115
  ds_write_b32 v114, v115
  s_cmp_lg_u64 s[0:1], 0
  s_cbranch_scc0 L_q_130
  s_waitcnt vmcnt(3)
L_q_130:
  s_waitcnt vmcnt(5)
  s_cbranch_vccnz L_p_129
  s_waitcnt vmcnt(4)
L_p_129:
  buffer_load_dwordx4 v[24:27], v2, s[8:11], s28 offen offset:256 nt
  s_add_u32 s28, s28, s77
  v_mfma_f32_16x16x32_bf16 v[100:103], v[84:87], v[32:35], v[100:103]
  v_add_u32 v115, 1, v115
  ds_write_b32 v114, v115
  s_cmp_lg_u64 s[0:1], 0
  s_cbranch_scc0 L_q_132
  s_waitcnt vmcnt(3)
L_q_132:
  s_waitcnt vmcnt(5)
  s_cbranch_vccnz L_p_131
  s_waitcnt vmcnt(4)
L_p_131:
  buffer_load_dwordx4 v[28:31], v2, s[8:11], s28 offen offset:0 nt
  v_mfma_f32_16x16x32_bf16 v[104:107], v[84:87], v[36:39], v[104:107]
  v_add_u32 v115, 1, v115
  ds_write_b32 v114, v115
  s_waitcnt lgkmcnt(1)
  v_cmp_gt_u32 vcc, v116, v115
  v_cmp_gt_u32 s[0:1], v117, v115
  ds_read_b64 v[116:117], v118 offset:64
  s_cmp_lg_u64 s[0:1], 0
  s_cbranch_scc0 L_q_134
  s_waitcnt vmcnt(3)
L_q_134:
  s_waitcnt vmcnt(5)
  s_cbranch_vccnz L_p_133
  s_waitcnt vmcnt(4)
L_p_133:
  buffer_load_dwordx4 v[32:35], v2, s[8:11], s28 offen offset:128 nt
  v_and_b32 v84, v94, v4
  v_and_b32 v85, v94, v5
  v_and_b32 v86, v94, v6
  v_and_b32 v87, v94, v7
  s_nop 1
  v_mfma_f32_16x16x32_bf16 v[96:99], v[84:87], v[40:43], v[96:99]
  v_add_u32 v115, 1, v115
  ds_write_b32 v114, v115
  s_cmp_lg_u64 s[0:1], 0
  s_cbranch_scc0 L_q_136
  s_waitcnt vmcnt(3)
L_q_136:
  s_waitcnt vmcnt(5)
  s_cbranch_vccnz L_p_135
  s_waitcnt vmcnt(4)
L_p_135:
  buffer_load_dwordx4 v[36:39], v2, s[8:11], s28 offen offset:256 nt
  s_add_u32 s28, s28, s77
  v_mfma_f32_16x16x32_bf16 v[100:103], v[84:87], v[44:47], v[100:103]
  v_add_u32 v115, 1, v115
  ds_write_b32 v114, v115
  s_cmp_lg_u64 s[0:1], 0
  s_cbranch_scc0 L_q_138
  s_waitcnt vmcnt(3)
L_q_138:
  s_waitcnt vmcnt(5)
  s_cbranch_vccnz L_p_137
  s_waitcnt vmcnt(4)
L_p_137:
  buffer_load_dwordx4 v[40:43], v2, s[8:11], s28 offen offset:0 nt
  v_mfma_f32_16x16x32_bf16 v[104:107], v[84:87], v[48:51], v[104:107]
  v_add_u32 v115, 1, v115
  ds_write_b32 v114, v115
  s_waitcnt lgkmcnt(1)
  v_cmp_gt_u32 vcc, v116, v115
  v_cmp_gt_u32 s[0:1], v117, v115
  ds_read_b64 v[116:117], v118 offset:64
  s_cmp_lg_u64 s[0:1], 0
  s_cbranch_scc0 L_q_140
  s_waitcnt vmcnt(3)
L_q_140:
  s_waitcnt vmcnt(5)
  s_cbranch_vccnz L_p_139
  s_waitcnt vmcnt(4)
L_p_139:
  buffer_load_dwordx4 v[44:47], v2, s[8:11], s28 offen offset:128 nt
  v_and_b32 v84, v95, v4
  v_and_b32 v85, v95, v5
  v_and_b32 v86, v95, v6
  v_and_b32 v87, v95, v7
  s_nop 1
  v_mfma_f32_16x16x32_bf16 v[96:99], v[84:87], v[52:55], v[96:99]
  v_add_u32 v115, 1, v115
  ds_write_b32 v114, v115
  s_cmp_lg_u64 s[0:1], 0
  s_cbranch_scc0 L_q_142
  s_waitcnt vmcnt(3)
L_q_142:
  s_waitcnt vmcnt(5)
  s_cbranch_vccnz L_p_141
  s_waitcnt vmcnt(4)
L_p_141:
  buffer_load_dwordx4 v[48:51], v2, s[8:11], s28 offen offset:256 nt
  s_add_u32 s28, s28, s77
  v_mfma_f32_16x16x32_bf16 v[100:103], v[84:87], v[56:59], v[100:103]
  v_add_u32 v115, 1, v115
  ds_write_b32 v114, v115
  s_cmp_lg_u64 s[0:1], 0
  s_cbranch_scc0 L_q_144
  s_waitcnt vmcnt(3)
L_q_144:
  s_waitcnt vmcnt(5)
  s_cbranch_vccnz L_p_143
  s_waitcnt vmcnt(4)
L_p_143:
  buffer_load_dwordx4 v[52:55], v2, s[8:11], s28 offen offset:0 nt
  v_mfma_f32_16x16x32_bf16 v[104:107], v[84:87], v[60:63], v[104:107]
  v_add_u32 v115, 1, v115
  ds_write_b32 v114, v115
  v_add_u32 v109, 32, v109
  s_add_u32 s30, s30, 1
  s_cmp_eq_u32 s30, 15
  s_cbranch_scc1 L_v_last
  s_bitcmp1_b32 0x11f0, s30
  s_cbranch_scc0 L_v_body
  s_mov_b64 exec, s[34:35]
  ds_write_b128 v111, v[96:99] offset:0
  ds_write_b128 v111, v[100:103] offset:256
  ds_write_b128 v111, v[104:107] offset:512
  s_mov_b64 exec, 1
  ds_add_u32 v112, v113 offset:32
  s_mov_b64 exec, -1
  v_add_u32 v112, 4, v112
  v_add_u32 v111, 6144, v111
  s_branch L_v
L_v_last:
  s_waitcnt vmcnt(7)
  buffer_load_dwordx4 v[56:59], v2, s[8:11], s28 offen offset:128 nt
  s_waitcnt lgkmcnt(0)
  v_and_b32 v84, v88, v4
  v_and_b32 v85, v88, v5
  v_and_b32 v86, v88, v6
  v_and_b32 v87, v88, v7
  ds_read_b128 v[92:95], v109 offset:16
  s_nop 0
  v_mfma_f32_16x16x32_bf16 v[96:99], v[84:87], v[16:19], v[96:99]
  s_waitcnt vmcnt(7)
  buffer_load_dwordx4 v[60:63], v2, s[8:11], s28 offen offset:256 nt
  s_add_u32 s28, s28, s77
  v_mfma_f32_16x16x32_bf16 v[100:103], v[84:87], v[20:23], v[100:103]
  s_waitcnt vmcnt(7)
  buffer_load_dwordx4 v[16:19], v2, s[8:11], s28 offen offset:0 nt
  v_mfma_f32_16x16x32_bf16 v[104:107], v[84:87], v[24:27], v[104:107]
  s_waitcnt vmcnt(7)
  buffer_load_dwordx4 v[20:23], v2, s[8:11], s28 offen offset:128 nt
  v_and_b32 v84, v89, v4
  v_and_b32 v85, v89, v5
  v_and_b32 v86, v89, v6
  v_and_b32 v87, v89, v7
  s_nop 1
  v_mfma_f32_16x16x32_bf16 v[96:99], v[84:87], v[28:31], v[96:99]
  s_waitcnt vmcnt(7)
  buffer_load_dwordx4 v[24:27], v2, s[8:11], s28 offen offset:256 nt
  s_add_u32 s28, s28, s77
  v_mfma_f32_16x16x32_bf16 v[100:103], v[84:87], v[32:35], v[100:103]
  s_waitcnt vmcnt(7)
  buffer_load_dwordx4 v[28:31], v2, s[8:11], s28 offen offset:0 nt
  v_mfma_f32_16x16x32_bf16 v[104:107], v[84:87], v[36:39], v[104:107]
  s_waitcnt vmcnt(7)
  buffer_load_dwordx4 v[32:35], v2, s[8:11], s28 offen offset:128 nt
  v_and_b32 v84, v90, v4
  v_and_b32 v85, v90, v5
  v_and_b32 v86, v90, v6
  v_and_b32 v87, v90, v7
  s_nop 1
  v_mfma_f32_16x16x32_bf16 v[96:99], v[84:87], v[40:43], v[96:99]
  s_waitcnt vmcnt(7)
  buffer_load_dwordx4 v[36:39], v2, s[8:11], s28 offen offset:256 nt
  s_add_u32 s28, s28, s77
  v_mfma_f32_16x16x32_bf16 v[100:103], v[84:87], v[44:47], v[100:103]
  s_waitcnt vmcnt(7)
  buffer_load_dwordx4 v[40:43], v2, s[8:11], s28 offen offset:0 nt
  v_mfma_f32_16x16x32_bf16 v[104:107], v[84:87], v[48:51], v[104:107]
  s_waitcnt vmcnt(7)
  buffer_load_dwordx4 v[44:47], v2, s[8:11], s28 offen offset:128 nt
  v_and_b32 v84, v91, v4
  v_and_b32 v85, v91, v5
  v_and_b32 v86, v91, v6
  v_and_b32 v87, v91, v7
  s_nop 1
  v_mfma_f32_16x16x32_bf16 v[96:99], v[84:87], v[52:55], v[96:99]
  s_waitcnt vmcnt(7)
  buffer_load_dwordx4 v[48:51], v2, s[8:11], s28 offen offset:256 nt
  s_add_u32 s28, s28, s77
  v_mfma_f32_16x16x32_bf16 v[100:103], v[84:87], v[56:59], v[100:103]
  s_waitcnt vmcnt(7)
  buffer_load_dwordx4 v[52:55], v2, s[8:11], s28 offen offset:0 nt
  v_mfma_f32_16x16x32_bf16 v[104:107], v[84:87], v[60:63], v[104:107]
  s_waitcnt vmcnt(7)
  buffer_load_dwordx4 v[56:59], v2, s[8:11], s28 offen offset:128 nt
  s_waitcnt lgkmcnt(0)
  v_and_b32 v84, v92, v4
  v_and_b32 v85, v92, v5
  v_and_b32 v86, v92, v6
  v_and_b32 v87, v92, v7
  s_nop 1
  v_mfma_f32_16x16x32_bf16 v[96:99], v[84:87], v[16:19], v[96:99]
  s_waitcnt vmcnt(7)
  buffer_load_dwordx4 v[60:63], v2, s[8:11], s28 offen offset:256 nt
  v_mfma_f32_16x16x32_bf16 v[100:103], v[84:87], v[20:23], v[100:103]
  s_waitcnt vmcnt(9)
  v_mfma_f32_16x16x32_bf16 v[104:107], v[84:87], v[24:27], v[104:107]
  s_waitcnt vmcnt(8)
  v_and_b32 v84, v93, v4
  v_and_b32 v85, v93, v5
  v_and_b32 v86, v93, v6
  v_and_b32 v87, v93, v7
  s_nop 1
  v_mfma_f32_16x16x32_bf16 v[96:99], v[84:87], v[28:31], v[96:99]
  s_waitcnt vmcnt(7)
  v_mfma_f32_16x16x32_bf16 v[100:103], v[84:87], v[32:35], v[100:103]
  s_waitcnt vmcnt(6)
  v_mfma_f32_16x16x32_bf16 v[104:107], v[84:87], v[36:39], v[104:107]
  s_waitcnt vmcnt(5)
  v_and_b32 v84, v94, v4
  v_and_b32 v85, v94, v5
  v_and_b32 v86, v94, v6
  v_and_b32 v87, v94, v7
  s_nop 1
  v_mfma_f32_16x16x32_bf16 v[96:99], v[84:87], v[40:43], v[96:99]
  s_waitcnt vmcnt(4)
  buffer_load_dwordx4 v[16:19], v119, s[12:15], s76 offen offset:0 nt
  buffer_load_dwordx4 v[20:23], v119, s[12:15], s76 offen offset:128 nt
  s_add_u32 s76, s76, 10240
  buffer_load_dwordx4 v[24:27], v119, s[12:15], s76 offen offset:0 nt
  buffer_load_dwordx4 v[28:31], v119, s[12:15], s76 offen offset:128 nt
  v_mfma_f32_16x16x32_bf16 v[100:103], v[84:87], v[44:47], v[100:103]
  s_waitcnt vmcnt(7)
  v_mfma_f32_16x16x32_bf16 v[104:107], v[84:87], v[48:51], v[104:107]
  s_waitcnt vmcnt(6)
  v_and_b32 v84, v95, v4
  v_and_b32 v85, v95, v5
  v_and_b32 v86, v95, v6
  v_and_b32 v87, v95, v7
  s_nop 1
  v_mfma_f32_16x16x32_bf16 v[96:99], v[84:87], v[52:55], v[96:99]
  s_waitcnt vmcnt(5)
  v_mfma_f32_16x16x32_bf16 v[100:103], v[84:87], v[56:59], v[100:103]
  s_waitcnt vmcnt(4)
  v_mfma_f32_16x16x32_bf16 v[104:107], v[84:87], v[60:63], v[104:107]
  s_mov_b64 exec, s[34:35]
  s_nop 2
  ds_write_b128 v111, v[96:99] offset:0
  s_nop 0
  ds_write_b128 v111, v[100:103] offset:256
  s_nop 0
  ds_write_b128 v111, v[104:107] offset:512
  s_mov_b64 exec, -1
  s_waitcnt lgkmcnt(0)
  s_barrier
  ds_read2_b32 v[88:89], v120 offset0:0 offset1:8
  s_waitcnt lgkmcnt(0)
  v_and_b32 v64, v88, v4
  v_and_b32 v65, v88, v5
  v_and_b32 v66, v88, v6
  v_and_b32 v67, v88, v7
  v_and_b32 v68, v89, v4
  v_and_b32 v69, v89, v5
  v_and_b32 v70, v89, v6
  v_and_b32 v71, v89, v7
  s_waitcnt vmcnt(3)
  v_mfma_f32_16x16x32_bf16 v[96:99], v[64:67], v[16:19], 0
  s_waitcnt vmcnt(2)
  v_mfma_f32_16x16x32_bf16 v[100:103], v[64:67], v[20:23], 0
  s_waitcnt vmcnt(1)
  v_mfma_f32_16x16x32_bf16 v[96:99], v[68:71], v[24:27], v[96:99]
  s_waitcnt vmcnt(0)
  v_mfma_f32_16x16x32_bf16 v[100:103], v[68:71], v[28:31], v[100:103]
  s_mov_b64 exec, s[34:35]
  s_nop 4
  ds_write_b128 v121, v[96:99] offset:24064
  s_nop 0
  ds_write_b128 v121, v[100:103] offset:24320
  s_mov_b64 exec, -1
  s_waitcnt lgkmcnt(0)
  s_barrier
  s_endpgm
L_ctl:
  s_waitcnt lgkmcnt(0)
  s_load_dword s6, s[58:59], 0
  s_mov_b64 s[16:17], s[58:59]
  s_mov_b32 s18, 1572864
  s_mov_b32 s19, 0x20000
  v_and_b32 v28, 3, v1
  v_lshlrev_b32 v2, 8, v28
  v_add_u32 v2, 113152, v2
  v_lshlrev_b32 v28, 3, v28
  v_and_b32 v14, 31, v1
  v_lshlrev_b32 v14, 2, v14
  s_lshl_b32 s28, s4, 7
  s_add_u32 s28, s28, 24576
  s_lshl_b32 s29, s5, 2
  v_mov_b32 v15, s29
  v_cmp_lt_u32 vcc, 31, v1
  v_mov_b32 v24, 1024
  s_nop 0
  v_cndmask_b32 v14, v14, v24, vcc
  v_mul_u32_u24 v24, 4352, v10
  s_lshl_b64 s[24:25], 1, s4
  s_cmp_eq_u32 s5, 30
  s_cbranch_scc0 L_ctl_npf
  v_lshrrev_b32 v34, 2, v1
  v_lshlrev_b32 v34, 12, v34
  v_and_b32 v35, 3, v1
  v_lshl_add_u32 v34, v35, 7, v34
  s_lshl_b32 s29, s4, 9
  s_add_u32 s29, s29, 4096
  s_mov_b64 exec, 0xffff
  buffer_load_dword v35, v34, s[16:19], s29 offen
  s_mov_b64 exec, -1
  buffer_load_dword v41, v14, s[16:19], s28 offen
  s_getpc_b64 s[12:13]
L_pc:
  s_sub_u32 s12, s12, L_pc-parallel_sum__mha_block_cached__glu_gated_reglu__decode_kernel
  s_subb_u32 s13, s13, 0
  v_lshlrev_b32 v36, 7, v1
  v_add_u32 v37, 0, v36
  v_min_u32 v37, L_end-parallel_sum__mha_block_cached__glu_gated_reglu__decode_kernel, v37
  global_load_dword v38, v37, s[12:13]
  v_add_u32 v37, 8192, v36
  v_min_u32 v37, L_end-parallel_sum__mha_block_cached__glu_gated_reglu__decode_kernel, v37
  global_load_dword v39, v37, s[12:13]
  v_add_u32 v37, 16384, v36
  v_min_u32 v37, L_end-parallel_sum__mha_block_cached__glu_gated_reglu__decode_kernel, v37
  global_load_dword v40, v37, s[12:13]
L_ctl_npf:
  s_waitcnt lgkmcnt(0)
  s_add_u32 s6, s6, 0x9e3779a0
  s_and_b32 s6, s6, 0xffff0000
  s_mov_b32 s33, 0x800000
L_w_145:
  ds_read_b32 v3, v2 offset:0
  s_waitcnt lgkmcnt(0)
  v_readfirstlane_b32 s32, v3
  s_nop 0
  s_cmp_ge_u32 s32, 1
  s_cbranch_scc1 L_d_146
  s_sleep 4
  s_sub_u32 s33, s33, 1
  s_cbranch_scc0 L_w_145
L_d_146:
  s_mov_b32 s33, 0x8000
  s_mov_b32 s20, 0
  s_mov_b32 s22, 0
  s_mov_b32 s32, 0
L_ctl_loop:
  s_sleep 10
L_ctl_fast:
  ds_read_b32 v16, v2
  s_waitcnt lgkmcnt(0)
  v_add_u32_dpp v17, v16, v16 quad_perm:[1,0,3,2] row_mask:0xf bank_mask:0xf
  s_nop 1
  v_add_u32_dpp v17, v17, v17 quad_perm:[2,3,0,1] row_mask:0xf bank_mask:0xf
  v_or_b32 v19, s6, v17
  v_readfirstlane_b32 s30, v17
  s_mov_b64 exec, 1
  buffer_store_dword v19, v15, s[16:19], s28 offen
  s_mov_b64 exec, -1
  s_cmp_ge_u32 s30, 2944
  s_cbranch_scc1 L_ctl_end
  buffer_load_dword v18, v14, s[16:19], s28 offen sc1
  s_add_u32 s21, s20, s30
  s_mov_b32 s20, s30
  v_lshlrev_b32 v29, 2, v16
  v_sub_u32 v29, v17, v29
  v_lshlrev_b32 v29, 6, v29
  s_waitcnt vmcnt(0)
  v_xor_b32 v18, s6, v18
  v_cmp_gt_u32 vcc, 0x10000, v18
  v_readlane_b32 s7, v18, 32
  v_lshlrev_b32 v18, 1, v18
  v_subrev_u32 v18, s21, v18
  v_cndmask_b32 v18, 0, v18, vcc
  s_nop 1
  v_add_u32_dpp v18, v18, v18 quad_perm:[1,0,3,2] row_mask:0xf bank_mask:0xf
  s_nop 1
  v_add_u32_dpp v18, v18, v18 quad_perm:[2,3,0,1] row_mask:0xf bank_mask:0xf
  s_nop 1
  v_add_u32_dpp v18, v18, v18 row_half_mirror row_mask:0xf bank_mask:0xf
  s_nop 1
  v_add_u32_dpp v18, v18, v18 row_mirror row_mask:0xf bank_mask:0xf
  v_mov_b32 v20, v18
  s_nop 1
  v_permlane16_swap_b32 v18, v20
  v_add_u32 v18, v18, v20
  s_nop 0
  v_readfirstlane_b32 s31, v18
  s_mov_b32 s1, 0
  s_cmp_eq_u32 s5, 0
  s_cbranch_scc0 L_ctl_np
  s_lshl_b32 s29, s21, 5
  s_add_u32 s29, s29, s31
  s_lshr_b32 s29, s29, 3
  s_add_u32 s26, s29, s22
  s_lshr_b32 s26, s26, 1
  s_mov_b32 s22, s29
  s_add_u32 s0, s29, 1408
  s_lshr_b32 s23, s0, 11
  s_sub_u32 s23, s23, 1
  s_and_b32 s0, s0, 2047
  s_cmp_lt_u32 s0, 768
  s_cbranch_scc0 L_ctl_np
  s_bitcmp1_b32 1706, s23
  s_cbranch_scc0 L_ctl_np
  s_mov_b32 s1, 1
  s_and_b32 s23, s23, 15
  s_lshl_b32 s27, s23, 8
  s_add_u32 s27, s27, 393216
  s_or_b32 s12, s29, s6
  v_mov_b32 v27, s12
  v_mov_b32 v26, s26
  s_mov_b64 exec, s[24:25]
  buffer_store_dword v27, v24, s[16:19], s27 offen sc1
  s_xor_b64 exec, exec, 0xff
  s_cmp_ge_u32 s0, 384
  s_cbranch_scc0 L_ctl_np
  s_bitcmp1_b32 s32, s23
  s_cbranch_scc1 L_ctl_np
  s_bitset1_b32 s32, s23
  buffer_load_dword v26, v24, s[16:19], s27 offen sc1
  s_waitcnt vmcnt(0)
  v_xor_b32 v26, s6, v26
  s_mov_b64 exec, -1
  v_cmp_gt_u32 vcc, 0x10000, v26
  v_subrev_u32 v26, s26, v26
  v_mov_b32 v27, 4294966912
  v_cndmask_b32 v26, v27, v26, vcc
  s_nop 1
  v_add_u32_dpp v26, v26, v26 quad_perm:[1,0,3,2] row_mask:0xf bank_mask:0xf
  s_nop 1
  v_add_u32_dpp v26, v26, v26 quad_perm:[2,3,0,1] row_mask:0xf bank_mask:0xf
  s_nop 1
  v_add_u32_dpp v26, v26, v26 row_half_mirror row_mask:0xf bank_mask:0xf
  s_nop 0
  v_readfirstlane_b32 s23, v26
  s_mov_b64 exec, 1
  s_add_i32 s23, s23, 307
  s_cmp_lt_i32 s23, 0
  s_cselect_b32 s0, 0x8000, 0
  s_abs_i32 s23, s23
  s_sub_i32 s23, s23, 128
  s_mul_i32 s23, s23, 12
  s_ashr_i32 s23, s23, 3
  s_add_i32 s23, s23, s29
  s_add_i32 s23, s23, 800
  s_lshr_b32 s23, s23, 5
  s_and_b32 s23, s23, 0x7fff
  s_or_b32 s23, s23, s0
  s_or_b32 s23, s23, s6
  s_mov_b32 exec_lo, -1
  v_mov_b32 v27, s23
  buffer_store_dword v27, v14, s[16:19], s28 offen offset:1024
L_ctl_np:
  s_mov_b64 exec, -1
  s_cmp_lt_u32 s7, 0x10000
  s_cselect_b32 s7, s7, 0
  s_bitcmp1_b32 s7, 15
  s_cselect_b32 s0, s7, 0
  s_cselect_b32 s7, 0, s7
  s_and_b32 s0, s0, 0x7fff
  v_add_u32 v29, s31, v29
  v_subrev_u32 v30, 0, v29
  v_sub_u32 v31, 4294966912, v29
  v_mul_i32_i24 v30, 5, v30
  v_mul_i32_i24 v31, 4, v31
  v_ashrrev_i32 v30, 8, v30
  v_ashrrev_i32 v31, 8, v31
  ds_read_b32 v16, v2
  s_waitcnt lgkmcnt(0)
  v_add_u32 v30, v30, v16
  v_add_u32 v31, v31, v16
  v_cmp_gt_i32 vcc, v31, v16
  v_cmp_gt_i32 s[10:11], v30, v16
  v_max_i32 v32, s7, v30
  v_max_i32 v33, s0, v31
  v_cndmask_b32 v30, v32, v30, vcc
  v_cndmask_b32 v31, v33, v31, s[10:11]
  v_max_i32 v30, 0, v30
  v_max_i32 v31, 0, v31
  s_mov_b64 exec, 15
  ds_write_b64 v28, v[30:31] offset:64
  s_mov_b64 exec, -1
  s_sub_u32 s33, s33, 1
  s_cbranch_scc1 L_ctl_end
  s_cmp_eq_u32 s1, 0
  s_cbranch_scc0 L_ctl_fast
  s_branch L_ctl_loop
L_ctl_end:
L_end:
  s_endpgm
.section .rodata,"a"
.p2align 6
.amdhsa_kernel parallel_sum__mha_block_cached__glu_gated_reglu__decode_kernel
  .amdhsa_next_free_vgpr 172
  .amdhsa_next_free_sgpr 80
  .amdhsa_accum_offset 172
  .amdhsa_group_segment_fixed_size 0
  .amdhsa_kernarg_size 96
  .amdhsa_user_sgpr_count 2
  .amdhsa_user_sgpr_kernarg_segment_ptr 1
  .amdhsa_system_sgpr_workgroup_id_x 1
  .amdhsa_float_denorm_mode_32 3
.end_amdhsa_kernel
```
